```python
import torch

def _softmax(x, axis=-1):
    return torch.softmax(x, dim=axis)

def _gelu(x):
    return torch.nn.functional.gelu(x, approximate='tanh')

def _silu(x):
    return torch.nn.functional.silu(x)

def _sigmoid(x):
    return torch.sigmoid(x)

def _layernorm(x, axis=-1, eps=1e-05):
    m = x.mean(dim=axis, keepdim=True)
    v = x.var(dim=axis, keepdim=True, unbiased=False)
    return (x - m) / torch.sqrt(v + eps)

def _scatter_add(tgt, idx, src, axis=0):
    return tgt.clone().index_add_(axis, idx, src)

def _segment_sum(src, seg, n):
    out = torch.zeros((n,) + src.shape[1:], dtype=src.dtype)
    return out.index_add_(0, seg, src)

def _pad(x, pw):
    flat = tuple((v for pair in reversed(pw) for v in pair))
    return torch.nn.functional.pad(x, flat)
kernel_name = 'standalone__dilated_atrous__vision'

def setup_inputs():

    _w = lambda a: (lambda t: t.to(torch.bfloat16) if t.is_floating_point() else t)(torch.as_tensor(a))
    H = W = 224
    C = 192
    k = 3
    return {'x': _w((lambda *s: torch.randn(*s, dtype=torch.bfloat16) * 0.05)(1, H, W, C)), 'w': _w((lambda *s: torch.randn(*s, dtype=torch.bfloat16) * 0.05)(k, k, C, C) * (1.0 / (k * C ** 0.5)))}

def reference(x, w):
    B, H, W, C = x.shape
    k = 3
    rate = 2
    pad = (k - 1) * rate // 2
    xp = _pad(x, ((0, 0), (pad, pad), (pad, pad), (0, 0)))
    out = torch.zeros_like(x)
    for i in range(k):
        for j in range(k):
            tap = xp[:, i * rate:i * rate + H, j * rate:j * rate + W, :].clone()
            out = out + torch.einsum('bhwc,co->bhwo', tap, w[i, j])
    return out
```

```asm
; @launch grid=(256,1,1) block=(256,1,1) lds=159744
.amdgcn_target "amdgcn-amd-amdhsa--gfx950"
.text
.globl standalone__dilated_atrous__vision_kernel
.p2align 8
.type standalone__dilated_atrous__vision_kernel,@function
standalone__dilated_atrous__vision_kernel:
    s_cmp_ge_u32 s2, 256
    s_cbranch_scc1 L_end
    s_load_dwordx8 s[4:11], s[0:1], 0
    s_load_dwordx2 s[12:13], s[0:1], 32
    v_lshrrev_b32 v1, 6, v0
    v_and_b32 v0, 63, v0
    s_cmp_lt_u32 s2, 32
    v_readfirstlane_b32 s28, v1
    s_cbranch_scc1 L_prod
    s_getpc_b64 s[14:15]
L_pc2:
    s_add_u32 s14, s14, L_main-L_pc2
    s_addc_u32 s15, s15, 0
    v_lshlrev_b32 v99, 7, v0
    s_cmp_eq_u32 s28, 1
    s_cbranch_scc0 L_nocpf2
    s_getpc_b64 s[98:99]
    global_load_dword v104, v99, s[98:99]
    global_load_dword v100, v99, s[14:15]
    v_add_u32 v99, 0x2000, v99
    global_load_dword v101, v99, s[14:15]
    v_add_u32 v99, 0x2000, v99
    global_load_dword v102, v99, s[14:15]
    v_add_u32 v99, 0x2000, v99
    global_load_dword v103, v99, s[14:15]
L_nocpf2:
    s_sub_u32 s92, s2, 32
    s_and_b32 s93, s92, 7
    s_lshr_b32 s92, s92, 3
    s_and_b32 s94, s92, 1
    s_lshr_b32 s95, s92, 1
    s_lshr_b32 s96, s93, 2
    s_mul_i32 s96, s96, 14
    s_and_b32 s92, s93, 3
    s_lshl_b32 s92, s92, 1
    s_add_u32 s92, s92, s94
    s_add_u32 s93, s95, s96
    s_mul_i32 s29, s92, 14
    s_mul_i32 s94, s93, 9363
    s_lshr_b32 s94, s94, 16
    s_mul_i32 s95, s94, 7
    s_sub_u32 s95, s93, s95
    s_lshl_b32 s30, s95, 4
    s_lshr_b32 s95, s94, 1
    s_and_b32 s94, s94, 1
    s_mul_i32 s95, s95, 86016
    s_mul_i32 s94, s94, 384
    s_add_u32 s94, s94, s95
    s_mul_i32 s95, s29, 172032
    s_mul_i32 s96, s30, 768
    s_add_u32 s95, s95, s96
    s_add_u32 s95, s95, s94
    v_lshlrev_b32 v77, 4, v0
    s_mul_i32 s39, s28, 6144
    s_mul_i32 s3, s28, 3072
    s_add_u32 s3, s3, 36864
    s_sub_u32 s14, s29, 1
    s_sub_u32 s15, s30, 1
    s_movk_i32 s96, 112
    s_mov_b32 s97, 172032
    s_movk_i32 s98, 3641
    s_mov_b32 s37, -18
    v_lshrrev_b32 v40, 3, v0
    v_and_b32 v41, 7, v0
    v_lshlrev_b32 v41, 4, v41
    s_lshl_b32 s99, s28, 3
    v_add_u32 v40, s99, v40
    v_bfrev_b32 v47, 1
    v_add_u32 v42, 0, v40
    v_mul_u32_u24 v43, s98, v42
    v_lshrrev_b32 v43, 16, v43
    v_mad_i32_i24 v44, v43, s37, v42
    v_lshrrev_b32 v46, 3, v43
    v_lshlrev_b32 v43, 1, v43
    v_mad_i32_i24 v43, v46, -15, v43
    v_lshrrev_b32 v45, 1, v44
    v_mad_i32_i24 v45, v45, -16, v41
    v_and_b32 v45, 0x70, v45
    v_add_u32 v43, s14, v43
    v_add_u32 v44, s15, v44
    v_cmp_gt_u32 s[100:101], s96, v43
    v_cmp_gt_u32 vcc, s96, v44
    v_mad_u32_u24 v45, v43, s97, v45
    v_mul_u32_u24 v44, 768, v44
    s_and_b64 vcc, vcc, s[100:101]
    v_add_u32 v45, v45, v44
    v_cndmask_b32 v1, v47, v45, vcc
    v_add_u32 v42, 32, v40
    v_mul_u32_u24 v43, s98, v42
    v_lshrrev_b32 v43, 16, v43
    v_mad_i32_i24 v44, v43, s37, v42
    v_lshrrev_b32 v46, 3, v43
    v_lshlrev_b32 v43, 1, v43
    v_mad_i32_i24 v43, v46, -15, v43
    v_lshrrev_b32 v45, 1, v44
    v_mad_i32_i24 v45, v45, -16, v41
    v_and_b32 v45, 0x70, v45
    v_add_u32 v43, s14, v43
    v_add_u32 v44, s15, v44
    v_cmp_gt_u32 s[100:101], s96, v43
    v_cmp_gt_u32 vcc, s96, v44
    v_mad_u32_u24 v45, v43, s97, v45
    v_mul_u32_u24 v44, 768, v44
    s_and_b64 vcc, vcc, s[100:101]
    v_add_u32 v45, v45, v44
    v_cndmask_b32 v2, v47, v45, vcc
    v_add_u32 v42, 64, v40
    v_mul_u32_u24 v43, s98, v42
    v_lshrrev_b32 v43, 16, v43
    v_mad_i32_i24 v44, v43, s37, v42
    v_lshrrev_b32 v46, 3, v43
    v_lshlrev_b32 v43, 1, v43
    v_mad_i32_i24 v43, v46, -15, v43
    v_lshrrev_b32 v45, 1, v44
    v_mad_i32_i24 v45, v45, -16, v41
    v_and_b32 v45, 0x70, v45
    v_add_u32 v43, s14, v43
    v_add_u32 v44, s15, v44
    v_cmp_gt_u32 s[100:101], s96, v43
    v_cmp_gt_u32 vcc, s96, v44
    v_mad_u32_u24 v45, v43, s97, v45
    v_mul_u32_u24 v44, 768, v44
    s_and_b64 vcc, vcc, s[100:101]
    v_add_u32 v45, v45, v44
    v_cndmask_b32 v3, v47, v45, vcc
    v_add_u32 v42, 96, v40
    v_mul_u32_u24 v43, s98, v42
    v_lshrrev_b32 v43, 16, v43
    v_mad_i32_i24 v44, v43, s37, v42
    v_lshrrev_b32 v46, 3, v43
    v_lshlrev_b32 v43, 1, v43
    v_mad_i32_i24 v43, v46, -15, v43
    v_lshrrev_b32 v45, 1, v44
    v_mad_i32_i24 v45, v45, -16, v41
    v_and_b32 v45, 0x70, v45
    v_add_u32 v43, s14, v43
    v_add_u32 v44, s15, v44
    v_cmp_gt_u32 s[100:101], s96, v43
    v_cmp_gt_u32 vcc, s96, v44
    v_mad_u32_u24 v45, v43, s97, v45
    v_mul_u32_u24 v44, 768, v44
    s_and_b64 vcc, vcc, s[100:101]
    v_add_u32 v45, v45, v44
    v_cndmask_b32 v4, v47, v45, vcc
    v_add_u32 v42, 128, v40
    v_mul_u32_u24 v43, s98, v42
    v_lshrrev_b32 v43, 16, v43
    v_mad_i32_i24 v44, v43, s37, v42
    v_lshrrev_b32 v46, 3, v43
    v_lshlrev_b32 v43, 1, v43
    v_mad_i32_i24 v43, v46, -15, v43
    v_lshrrev_b32 v45, 1, v44
    v_mad_i32_i24 v45, v45, -16, v41
    v_and_b32 v45, 0x70, v45
    v_add_u32 v43, s14, v43
    v_add_u32 v44, s15, v44
    v_cmp_gt_u32 s[100:101], s96, v43
    v_cmp_gt_u32 vcc, s96, v44
    v_mad_u32_u24 v45, v43, s97, v45
    v_mul_u32_u24 v44, 768, v44
    s_and_b64 vcc, vcc, s[100:101]
    v_add_u32 v45, v45, v44
    v_cndmask_b32 v5, v47, v45, vcc
    v_add_u32 v42, 160, v40
    v_mul_u32_u24 v43, s98, v42
    v_lshrrev_b32 v43, 16, v43
    v_mad_i32_i24 v44, v43, s37, v42
    v_lshrrev_b32 v46, 3, v43
    v_lshlrev_b32 v43, 1, v43
    v_mad_i32_i24 v43, v46, -15, v43
    v_lshrrev_b32 v45, 1, v44
    v_mad_i32_i24 v45, v45, -16, v41
    v_and_b32 v45, 0x70, v45
    v_add_u32 v43, s14, v43
    v_add_u32 v44, s15, v44
    v_cmp_gt_u32 s[100:101], s96, v43
    v_cmp_gt_u32 vcc, s96, v44
    v_mad_u32_u24 v45, v43, s97, v45
    v_mul_u32_u24 v44, 768, v44
    s_and_b64 vcc, vcc, s[100:101]
    v_add_u32 v45, v45, v44
    v_cndmask_b32 v6, v47, v45, vcc
    v_add_u32 v42, 192, v40
    v_mul_u32_u24 v43, s98, v42
    v_lshrrev_b32 v43, 16, v43
    v_mad_i32_i24 v44, v43, s37, v42
    v_lshrrev_b32 v46, 3, v43
    v_lshlrev_b32 v43, 1, v43
    v_mad_i32_i24 v43, v46, -15, v43
    v_lshrrev_b32 v45, 1, v44
    v_mad_i32_i24 v45, v45, -16, v41
    v_and_b32 v45, 0x70, v45
    v_add_u32 v43, s14, v43
    v_add_u32 v44, s15, v44
    v_cmp_gt_u32 s[100:101], s96, v43
    v_cmp_gt_u32 vcc, s96, v44
    v_mad_u32_u24 v45, v43, s97, v45
    v_mul_u32_u24 v44, 768, v44
    s_and_b64 vcc, vcc, s[100:101]
    v_add_u32 v45, v45, v44
    v_cndmask_b32 v7, v47, v45, vcc
    v_add_u32 v42, 224, v40
    v_mul_u32_u24 v43, s98, v42
    v_lshrrev_b32 v43, 16, v43
    v_mad_i32_i24 v44, v43, s37, v42
    v_lshrrev_b32 v46, 3, v43
    v_lshlrev_b32 v43, 1, v43
    v_mad_i32_i24 v43, v46, -15, v43
    v_lshrrev_b32 v45, 1, v44
    v_mad_i32_i24 v45, v45, -16, v41
    v_and_b32 v45, 0x70, v45
    v_add_u32 v43, s14, v43
    v_add_u32 v44, s15, v44
    v_cmp_gt_u32 s[100:101], s96, v43
    v_cmp_gt_u32 vcc, s96, v44
    v_mad_u32_u24 v45, v43, s97, v45
    v_mul_u32_u24 v44, 768, v44
    s_and_b64 vcc, vcc, s[100:101]
    v_add_u32 v45, v45, v44
    v_cndmask_b32 v8, v47, v45, vcc
    v_add_u32 v42, 256, v40
    v_mul_u32_u24 v43, s98, v42
    v_lshrrev_b32 v43, 16, v43
    v_mad_i32_i24 v44, v43, s37, v42
    v_lshrrev_b32 v46, 3, v43
    v_lshlrev_b32 v43, 1, v43
    v_mad_i32_i24 v43, v46, -15, v43
    v_lshrrev_b32 v45, 1, v44
    v_mad_i32_i24 v45, v45, -16, v41
    v_and_b32 v45, 0x70, v45
    v_add_u32 v43, s14, v43
    v_add_u32 v44, s15, v44
    v_cmp_gt_u32 s[100:101], s96, v43
    v_cmp_gt_u32 vcc, s96, v44
    v_mad_u32_u24 v45, v43, s97, v45
    v_mul_u32_u24 v44, 768, v44
    s_and_b64 vcc, vcc, s[100:101]
    v_add_u32 v45, v45, v44
    v_cndmask_b32 v9, v47, v45, vcc
    s_waitcnt lgkmcnt(0)
    s_add_u32 s16, s4, s94
    s_addc_u32 s17, s5, 0
    s_sub_u32 s18, 19267584, s94
    s_mov_b32 s19, 0x20000
    s_mov_b32 s4, s6
    s_mov_b32 s5, s7
    s_mov_b32 s6, 663552
    s_mov_b32 s7, 0x20000
    s_mov_b32 s32, 128
    s_mov_b32 s33, 256
    s_lshl_b32 s35, s28, 10
    s_add_u32 m0, s35, 0
    s_nop 0
    buffer_load_dwordx4 v1, s[16:19], 0 offen lds
    s_add_u32 m0, s35, 4096
    s_nop 0
    buffer_load_dwordx4 v2, s[16:19], 0 offen lds
    s_add_u32 m0, s35, 8192
    s_nop 0
    buffer_load_dwordx4 v3, s[16:19], 0 offen lds
    s_add_u32 m0, s35, 12288
    s_nop 0
    buffer_load_dwordx4 v4, s[16:19], 0 offen lds
    s_add_u32 m0, s35, 16384
    s_nop 0
    buffer_load_dwordx4 v5, s[16:19], 0 offen lds
    s_add_u32 s31, s39, 0
    s_add_u32 m0, s3, 0
    s_nop 0
    buffer_load_dwordx4 v77, s[4:7], s31 offen offset:0 lds
    buffer_load_dwordx4 v77, s[4:7], s31 offen offset:1024 lds
    buffer_load_dwordx4 v77, s[4:7], s31 offen offset:2048 lds
    s_add_u32 m0, s35, 20480
    s_nop 0
    buffer_load_dwordx4 v6, s[16:19], 0 offen lds
    s_add_u32 m0, s35, 24576
    s_nop 0
    buffer_load_dwordx4 v7, s[16:19], 0 offen lds
    s_add_u32 m0, s35, 28672
    s_nop 0
    buffer_load_dwordx4 v8, s[16:19], 0 offen lds
    s_add_u32 m0, s35, 32768
    s_nop 0
    buffer_load_dwordx4 v9, s[16:19], 0 offen lds
    v_lshrrev_b32 v42, 4, v0
    v_bfe_u32 v43, v0, 2, 2
    v_and_b32 v44, 3, v0
    v_mul_u32_u24 v46, 3072, v42
    v_mul_u32_u24 v48, 384, v43
    v_add_u32 v46, v46, v48
    v_add_u32 v46, 36864, v46
    s_lshl_b32 s99, s28, 6
    v_lshl_add_u32 v48, v44, 4, v46
    v_add_u32 v78, s99, v48
    s_lshl_b32 s99, s28, 5
    s_add_u32 s99, s99, 256
    v_lshl_add_u32 v48, v44, 3, v46
    v_add_u32 v76, s99, v48
    v_lshrrev_b32 v66, 4, v0
    v_and_b32 v67, 15, v0
    s_mov_b32 s98, 0x54107632
    s_mov_b32 s99, 0xfebadc98
    v_lshlrev_b32 v68, 2, v67
    v_lshrrev_b64 v[68:69], v68, s[98:99]
    v_and_b32 v68, 15, v68
    v_add_u32 v69, 0, v68
    v_lshrrev_b32 v70, 1, v69
    v_lshl_add_u32 v70, v66, 1, v70
    v_add_u32 v71, 0, v70
    v_and_b32 v71, 7, v71
    v_lshlrev_b32 v71, 4, v71
    v_lshl_add_u32 v71, v69, 7, v71
    v_add_u32 v10, 110592, v71
    v_add_u32 v71, 1, v70
    v_and_b32 v71, 7, v71
    v_lshlrev_b32 v71, 4, v71
    v_lshl_add_u32 v71, v69, 7, v71
    v_add_u32 v11, 110592, v71
    v_add_u32 v69, 1, v68
    v_lshrrev_b32 v70, 1, v69
    v_lshl_add_u32 v70, v66, 1, v70
    v_add_u32 v71, 0, v70
    v_and_b32 v71, 7, v71
    v_lshlrev_b32 v71, 4, v71
    v_lshl_add_u32 v71, v69, 7, v71
    v_add_u32 v12, 110592, v71
    v_add_u32 v71, 1, v70
    v_and_b32 v71, 7, v71
    v_lshlrev_b32 v71, 4, v71
    v_lshl_add_u32 v71, v69, 7, v71
    v_add_u32 v13, 110592, v71
    v_add_u32 v69, 2, v68
    v_lshrrev_b32 v70, 1, v69
    v_lshl_add_u32 v70, v66, 1, v70
    v_add_u32 v71, 0, v70
    v_and_b32 v71, 7, v71
    v_lshlrev_b32 v71, 4, v71
    v_lshl_add_u32 v71, v69, 7, v71
    v_add_u32 v14, 110592, v71
    v_add_u32 v71, 1, v70
    v_and_b32 v71, 7, v71
    v_lshlrev_b32 v71, 4, v71
    v_lshl_add_u32 v71, v69, 7, v71
    v_add_u32 v15, 110592, v71
    s_lshl_b32 s98, s28, 6
    v_add_u32 v69, s98, v0
    s_movk_i32 s98, 7282
    s_movk_i32 s99, 2304
    v_add_u32 v70, 0, v69
    v_mul_u32_u24 v71, s98, v70
    v_lshrrev_b32 v71, 20, v71
    v_lshlrev_b32 v70, 4, v70
    v_add_u32 v16, 110592, v70
    v_mov_b32 v20, v70
    v_add_u32 v24, 36864, v20
    v_add_u32 v70, 256, v69
    v_mul_u32_u24 v71, s98, v70
    v_lshrrev_b32 v71, 20, v71
    v_lshlrev_b32 v70, 4, v70
    v_add_u32 v17, 110592, v70
    v_mov_b32 v21, v70
    v_add_u32 v25, 36864, v21
    v_add_u32 v70, 512, v69
    v_mul_u32_u24 v71, s98, v70
    v_lshrrev_b32 v71, 20, v71
    v_lshlrev_b32 v70, 4, v70
    v_add_u32 v18, 110592, v70
    v_mov_b32 v22, v70
    v_add_u32 v26, 36864, v22
    v_add_u32 v70, 768, v69
    v_mul_u32_u24 v71, s98, v70
    v_lshrrev_b32 v71, 20, v71
    v_lshlrev_b32 v70, 4, v70
    v_add_u32 v19, 110592, v70
    v_mov_b32 v23, v70
    v_add_u32 v27, 36864, v23
    s_mul_i32 s98, s28, 3072
    v_lshlrev_b32 v69, 4, v0
    v_add_u32 v28, s98, v69
    v_mul_u32_u24 v69, 768, v68
    s_lshl_b32 s98, s28, 6
    v_lshl_add_u32 v70, v66, 4, v69
    v_add_u32 v29, s98, v70
    s_lshl_b32 s98, s28, 5
    s_add_u32 s98, s98, 256
    v_lshrrev_b32 v70, 1, v66
    v_lshl_add_u32 v70, v70, 4, v69
    v_and_b32 v71, 1, v66
    v_lshlrev_b32 v71, 1, v71
    v_mad_u32_u24 v70, v71, s97, v70
    v_add_u32 v30, s98, v70
    v_lshl_add_u32 v70, v66, 3, v69
    v_add_u32 v79, s98, v70
    v_lshrrev_b32 v69, 5, v0
    v_lshlrev_b32 v69, 2, v69
    v_add_u32 v31, 132, v69
    s_mov_b32 s20, s12
    s_mov_b32 s21, s13
    s_mov_b32 s22, 811008
    s_mov_b32 s23, 0x20000
    s_add_u32 s24, s8, s95
    s_addc_u32 s25, s9, 0
    s_sub_u32 s26, 19267584, s95
    s_mov_b32 s27, 0x20000
    s_mov_b32 s36, 0xffff0000
    s_cmp_eq_u32 s28, 1
    s_cbranch_scc0 L_notour
    s_waitcnt vmcnt(12)
    s_mov_b64 vcc, -1
    s_branch L_propad
L_tourend:
L_notour:
    s_mov_b64 vcc, 0
    s_waitcnt vmcnt(4)
    s_barrier
    ds_read_b128 v[32:35], v20 offset:0
    ds_read_b128 v[36:39], v20 offset:2304
    ds_read_b128 v[40:43], v21 offset:0
    ds_read_b128 v[44:47], v21 offset:2304
    ds_read_b128 v[108:111], v22 offset:0
    ds_read_b128 v[112:115], v22 offset:2304
    ds_read_b128 v[84:87], v23 offset:0
    ds_read_b128 v[88:91], v23 offset:2304
    ds_read_b64_tr_b16 a[32:33], v78 offset:0
    ds_read_b64_tr_b16 a[36:37], v78 offset:8
    ds_read_b64_tr_b16 a[40:41], v76 offset:0
    ds_read_b64_tr_b16 a[34:35], v78 offset:1536
    ds_read_b64_tr_b16 a[38:39], v78 offset:1544
    ds_read_b64_tr_b16 a[42:43], v76 offset:1536
    s_waitcnt lgkmcnt(12)
    s_add_u32 s31, s39, 3072
    s_add_u32 m0, s3, 12288
    v_lshlrev_b32 v48, 16, v32
    v_lshlrev_b32 v49, 16, v36
    v_and_b32 v50, s36, v32
    v_and_b32 v51, s36, v36
    buffer_load_dwordx4 v77, s[4:7], s31 offen offset:0 lds
    v_lshlrev_b32 v80, 16, v33
    v_lshlrev_b32 v81, 16, v37
    v_sub_f32 v48, v48, v49 div:2
    v_sub_f32 v50, v50, v51 div:2
    v_and_b32 v82, s36, v33
    v_and_b32 v83, s36, v37
    v_cvt_pk_bf16_f32 v52, v48, v50
    v_sub_f32 v80, v80, v81 div:2
    buffer_load_dwordx4 v77, s[4:7], s31 offen offset:1024 lds
    v_lshlrev_b32 v48, 16, v34
    v_sub_f32 v82, v82, v83 div:2
    v_lshlrev_b32 v49, 16, v38
    v_and_b32 v50, s36, v34
    v_and_b32 v51, s36, v38
    v_cvt_pk_bf16_f32 v53, v80, v82
    v_lshlrev_b32 v80, 16, v35
    v_sub_f32 v48, v48, v49 div:2
    buffer_load_dwordx4 v77, s[4:7], s31 offen offset:2048 lds
    v_lshlrev_b32 v81, 16, v39
    v_sub_f32 v50, v50, v51 div:2
    v_and_b32 v82, s36, v35
    v_and_b32 v83, s36, v39
    v_cvt_pk_bf16_f32 v54, v48, v50
    v_sub_f32 v80, v80, v81 div:2
    v_sub_f32 v82, v82, v83 div:2
    v_cvt_pk_bf16_f32 v55, v80, v82
    ds_write_b128 v16, v[52:55] offset:0
    s_waitcnt lgkmcnt(11)
    s_add_u32 s31, s39, 73728
    s_add_u32 m0, s3, 24576
    v_lshlrev_b32 v48, 16, v40
    v_lshlrev_b32 v49, 16, v44
    v_and_b32 v50, s36, v40
    v_and_b32 v51, s36, v44
    buffer_load_dwordx4 v77, s[4:7], s31 offen offset:0 lds
    v_lshlrev_b32 v80, 16, v41
    v_lshlrev_b32 v81, 16, v45
    v_sub_f32 v48, v48, v49 div:2
    v_sub_f32 v50, v50, v51 div:2
    v_and_b32 v82, s36, v41
    v_and_b32 v83, s36, v45
    v_cvt_pk_bf16_f32 v56, v48, v50
    v_sub_f32 v80, v80, v81 div:2
    buffer_load_dwordx4 v77, s[4:7], s31 offen offset:1024 lds
    v_lshlrev_b32 v48, 16, v42
    v_sub_f32 v82, v82, v83 div:2
    v_lshlrev_b32 v49, 16, v46
    v_and_b32 v50, s36, v42
    v_and_b32 v51, s36, v46
    v_cvt_pk_bf16_f32 v57, v80, v82
    v_lshlrev_b32 v80, 16, v43
    v_sub_f32 v48, v48, v49 div:2
    buffer_load_dwordx4 v77, s[4:7], s31 offen offset:2048 lds
    v_lshlrev_b32 v81, 16, v47
    v_sub_f32 v50, v50, v51 div:2
    v_and_b32 v82, s36, v43
    v_and_b32 v83, s36, v47
    v_cvt_pk_bf16_f32 v58, v48, v50
    v_sub_f32 v80, v80, v81 div:2
    v_sub_f32 v82, v82, v83 div:2
    v_cvt_pk_bf16_f32 v59, v80, v82
    ds_write_b128 v17, v[56:59] offset:0
    s_waitcnt lgkmcnt(10)
    s_add_u32 s31, s39, 76800
    s_add_u32 m0, s3, 36864
    v_lshlrev_b32 v48, 16, v108
    v_lshlrev_b32 v49, 16, v112
    v_and_b32 v50, s36, v108
    v_and_b32 v51, s36, v112
    buffer_load_dwordx4 v77, s[4:7], s31 offen offset:0 lds
    v_lshlrev_b32 v80, 16, v109
    v_lshlrev_b32 v81, 16, v113
    v_sub_f32 v48, v48, v49 div:2
    v_sub_f32 v50, v50, v51 div:2
    v_and_b32 v82, s36, v109
    v_and_b32 v83, s36, v113
    v_cvt_pk_bf16_f32 v52, v48, v50
    v_sub_f32 v80, v80, v81 div:2
    buffer_load_dwordx4 v77, s[4:7], s31 offen offset:1024 lds
    v_lshlrev_b32 v48, 16, v110
    v_sub_f32 v82, v82, v83 div:2
    v_lshlrev_b32 v49, 16, v114
    v_and_b32 v50, s36, v110
    v_and_b32 v51, s36, v114
    v_cvt_pk_bf16_f32 v53, v80, v82
    v_lshlrev_b32 v80, 16, v111
    v_sub_f32 v48, v48, v49 div:2
    buffer_load_dwordx4 v77, s[4:7], s31 offen offset:2048 lds
    v_lshlrev_b32 v81, 16, v115
    v_sub_f32 v50, v50, v51 div:2
    v_and_b32 v82, s36, v111
    v_and_b32 v83, s36, v115
    v_cvt_pk_bf16_f32 v54, v48, v50
    v_sub_f32 v80, v80, v81 div:2
    v_sub_f32 v82, v82, v83 div:2
    v_cvt_pk_bf16_f32 v55, v80, v82
    ds_write_b128 v18, v[52:55] offset:0
    s_waitcnt lgkmcnt(9)
    v_lshlrev_b32 v48, 16, v84
    v_lshlrev_b32 v49, 16, v88
    v_and_b32 v50, s36, v84
    v_and_b32 v51, s36, v88
    v_lshlrev_b32 v80, 16, v85
    v_lshlrev_b32 v81, 16, v89
    v_sub_f32 v48, v48, v49 div:2
    v_sub_f32 v50, v50, v51 div:2
    v_and_b32 v82, s36, v85
    v_and_b32 v83, s36, v89
    v_cvt_pk_bf16_f32 v56, v48, v50
    v_sub_f32 v80, v80, v81 div:2
    v_lshlrev_b32 v48, 16, v86
    v_sub_f32 v82, v82, v83 div:2
    v_lshlrev_b32 v49, 16, v90
    v_and_b32 v50, s36, v86
    v_and_b32 v51, s36, v90
    v_cvt_pk_bf16_f32 v57, v80, v82
    v_lshlrev_b32 v80, 16, v87
    v_sub_f32 v48, v48, v49 div:2
    v_lshlrev_b32 v81, 16, v91
    v_sub_f32 v50, v50, v51 div:2
    v_and_b32 v82, s36, v87
    v_and_b32 v83, s36, v91
    v_cvt_pk_bf16_f32 v58, v48, v50
    v_sub_f32 v80, v80, v81 div:2
    v_sub_f32 v82, v82, v83 div:2
    v_cvt_pk_bf16_f32 v59, v80, v82
    ds_write_b128 v19, v[56:59] offset:0
    s_waitcnt vmcnt(9)
    s_barrier
    ds_read_b128 v[92:95], v20 offset:18432
    ds_read_b128 v[96:99], v20 offset:2304
    ds_read_b128 v[100:103], v21 offset:18432
    ds_read_b128 v[104:107], v21 offset:2304
    s_waitcnt lgkmcnt(2)
    v_lshlrev_b32 v48, 16, v92
    v_lshlrev_b32 v49, 16, v96
    v_and_b32 v50, s36, v92
    v_and_b32 v51, s36, v96
    v_lshlrev_b32 v80, 16, v93
    v_lshlrev_b32 v81, 16, v97
    v_and_b32 v82, s36, v93
    v_and_b32 v83, s36, v97
    v_add_f32 v60, v48, v49
    v_add_f32 v52, v50, v51
    v_sub_f32 v48, v49, v48
    v_sub_f32 v50, v51, v50
    v_add_f32 v61, v80, v81
    v_add_f32 v53, v82, v83
L_propad:
    s_cbranch_vccnz L_main
    v_sub_f32 v80, v81, v80
    v_sub_f32 v82, v83, v82
    v_cvt_pk_bf16_f32 v60, v60, v52
    v_cvt_pk_bf16_f32 v52, v48, v50
    v_lshlrev_b32 v48, 16, v94
    v_lshlrev_b32 v49, 16, v98
    v_and_b32 v50, s36, v94
    v_and_b32 v51, s36, v98
    v_cvt_pk_bf16_f32 v61, v61, v53
    v_cvt_pk_bf16_f32 v53, v80, v82
    v_lshlrev_b32 v80, 16, v95
    v_lshlrev_b32 v81, 16, v99
    v_and_b32 v82, s36, v95
    v_and_b32 v83, s36, v99
    v_add_f32 v62, v48, v49
    v_add_f32 v54, v50, v51
    v_sub_f32 v48, v49, v48
    v_sub_f32 v50, v51, v50
    v_add_f32 v63, v80, v81
    v_add_f32 v55, v82, v83
    v_sub_f32 v80, v81, v80
    v_sub_f32 v82, v83, v82
    v_cvt_pk_bf16_f32 v62, v62, v54
    v_cvt_pk_bf16_f32 v54, v48, v50
    v_cvt_pk_bf16_f32 v63, v63, v55
    v_cvt_pk_bf16_f32 v55, v80, v82
    s_nop 1
    ds_write_b128 v16, v[52:55] offset:16384
    s_waitcnt lgkmcnt(1)
    v_lshlrev_b32 v48, 16, v100
    v_lshlrev_b32 v49, 16, v104
    v_and_b32 v50, s36, v100
    v_and_b32 v51, s36, v104
    v_lshlrev_b32 v80, 16, v101
    v_lshlrev_b32 v81, 16, v105
    v_and_b32 v82, s36, v101
    v_and_b32 v83, s36, v105
    v_add_f32 v64, v48, v49
    v_add_f32 v56, v50, v51
    v_sub_f32 v48, v49, v48
    v_sub_f32 v50, v51, v50
    v_add_f32 v65, v80, v81
    v_add_f32 v57, v82, v83
    v_sub_f32 v80, v81, v80
    v_sub_f32 v82, v83, v82
    v_cvt_pk_bf16_f32 v64, v64, v56
    v_cvt_pk_bf16_f32 v56, v48, v50
    v_lshlrev_b32 v48, 16, v102
    v_lshlrev_b32 v49, 16, v106
    v_and_b32 v50, s36, v102
    v_and_b32 v51, s36, v106
    v_cvt_pk_bf16_f32 v65, v65, v57
    v_cvt_pk_bf16_f32 v57, v80, v82
    v_lshlrev_b32 v80, 16, v103
    v_lshlrev_b32 v81, 16, v107
    v_and_b32 v82, s36, v103
    v_and_b32 v83, s36, v107
    v_add_f32 v66, v48, v49
    v_add_f32 v58, v50, v51
    v_sub_f32 v48, v49, v48
    v_sub_f32 v50, v51, v50
    v_add_f32 v67, v80, v81
    v_add_f32 v59, v82, v83
    v_sub_f32 v80, v81, v80
    v_sub_f32 v82, v83, v82
    v_cvt_pk_bf16_f32 v66, v66, v58
    v_cvt_pk_bf16_f32 v58, v48, v50
    v_cvt_pk_bf16_f32 v67, v67, v59
    v_cvt_pk_bf16_f32 v59, v80, v82
    ds_write_b128 v17, v[56:59] offset:16384
    s_waitcnt lgkmcnt(0)
    s_barrier
    ds_read_b128 a[0:3], v10 offset:0
    ds_read_b128 a[4:7], v10 offset:2304
    ds_read_b128 a[8:11], v10 offset:4608
    ds_read_b128 a[12:15], v10 offset:6912
    ds_read_b128 a[16:19], v10 offset:9216
    ds_read_b128 a[20:23], v10 offset:11520
    ds_read_b128 a[24:27], v10 offset:13824
    s_branch L_main
L_prod:
    s_cmp_ge_u32 s2, 27
    s_cbranch_scc1 L_idle
    s_and_b32 s93, s2, 7
    s_lshr_b32 s94, s2, 3
    s_mul_i32 s95, s94, 3
    s_add_u32 s96, s95, s93
    s_add_u32 s97, s96, 15
    s_cmp_eq_u32 s94, 3
    s_cselect_b32 s96, s97, s96
    s_sub_u32 s97, s93, 5
    s_cmp_eq_u32 s93, 3
    s_cselect_b32 s97, 0, s97
    s_add_u32 s97, s97, s95
    s_add_u32 s97, s97, 9
    s_lshl_b32 s98, s94, 1
    s_add_u32 s98, s98, s93
    s_add_u32 s98, s98, 14
    s_cmp_lt_u32 s93, 3
    s_cselect_b32 s99, s96, s97
    s_sub_u32 s3, s93, 4
    s_cmp_lt_u32 s3, 2
    s_cselect_b32 s74, s98, s99
    s_mul_i32 s92, s74, 7282
    s_lshr_b32 s92, s92, 16
    s_mul_i32 s93, s92, 9
    s_sub_u32 s93, s74, s93
    s_mul_i32 s94, s93, 21846
    s_lshr_b32 s94, s94, 16
    s_mul_i32 s95, s94, 3
    s_sub_u32 s95, s93, s95
    s_mul_i32 s96, s94, 73728
    s_mul_i32 s97, s92, 24576
    s_add_u32 s96, s96, s97
    s_lshl_b32 s97, s95, 7
    s_add_u32 s96, s96, s97
    v_lshrrev_b32 v1, 3, v0
    v_mul_u32_u24 v1, 384, v1
    v_and_b32 v2, 7, v0
    v_lshl_add_u32 v1, v2, 4, v1
    s_mul_i32 s97, s28, 3072
    s_add_u32 s96, s96, s97
    s_lshl_b32 s98, s28, 10
    s_waitcnt lgkmcnt(0)
    s_mov_b32 s16, s6
    s_mov_b32 s17, s7
    s_mov_b32 s18, 663552
    s_mov_b32 s19, 0x20000
    s_add_u32 s99, s96, 0
    s_add_u32 m0, s98, 0
    s_nop 0
    buffer_load_dwordx4 v1, s[16:19], s99 offen lds
    s_add_u32 s99, s96, 12288
    s_add_u32 m0, s98, 4096
    s_nop 0
    buffer_load_dwordx4 v1, s[16:19], s99 offen lds
    s_add_u32 s99, s96, 221184
    s_add_u32 m0, s98, 8192
    s_nop 0
    buffer_load_dwordx4 v1, s[16:19], s99 offen lds
    s_add_u32 s99, s96, 233472
    s_add_u32 m0, s98, 12288
    s_nop 0
    buffer_load_dwordx4 v1, s[16:19], s99 offen lds
    s_add_u32 s99, s96, 442368
    s_add_u32 m0, s98, 16384
    s_nop 0
    buffer_load_dwordx4 v1, s[16:19], s99 offen lds
    s_add_u32 s99, s96, 454656
    s_add_u32 m0, s98, 20480
    s_nop 0
    buffer_load_dwordx4 v1, s[16:19], s99 offen lds
    s_mov_b32 s20, s12
    s_mov_b32 s21, s13
    s_mov_b32 s22, 811008
    s_mov_b32 s23, 0x20000
    v_lshrrev_b32 v2, 4, v0
    v_bfe_u32 v3, v0, 2, 2
    v_and_b32 v4, 3, v0
    v_lshl_add_u32 v2, v2, 4, v3
    v_lshlrev_b32 v2, 7, v2
    s_lshr_b32 s97, s28, 1
    s_lshl_b32 s97, s97, 6
    s_and_b32 s99, s28, 1
    s_lshl_b32 s99, s99, 3
    s_add_u32 s97, s97, s99
    s_lshl_b32 s99, s28, 5
    s_cmp_eq_u32 s95, 2
    s_cselect_b32 s97, s99, s97
    s_cselect_b32 s99, 3, 4
    v_lshlrev_b32 v4, s99, v4
    v_add_u32 v2, v2, v4
    v_add_u32 v2, s97, v2
    s_lshr_b32 s97, s28, 1
    s_lshl_b32 s99, s95, 1
    s_add_u32 s97, s97, s99
    s_mul_i32 s97, s97, 3
    s_and_b32 s99, s28, 1
    s_add_u32 s97, s97, s99
    s_mul_i32 s99, s28, 3
    s_add_u32 s99, s99, 2
    s_cmp_eq_u32 s95, 2
    s_cselect_b32 s97, s99, s97
    s_lshl_b32 s97, s97, 10
    s_mul_i32 s98, s92, 12
    s_lshl_b32 s99, s94, 1
    s_add_u32 s98, s98, s99
    s_mul_i32 s98, s98, 12288
    s_add_u32 s70, s98, s97
    s_mul_i32 s98, s92, 6
    s_add_u32 s98, s98, s99
    s_mul_i32 s98, s98, 12288
    s_add_u32 s71, s98, s97
    v_lshlrev_b32 v7, 4, v0
    s_mov_b32 s72, 0xffff0000
    s_waitcnt vmcnt(0)
    s_barrier
    ds_read_b64_tr_b16 v[16:17], v2 offset:0
    ds_read_b64_tr_b16 v[18:19], v2 offset:512
    ds_read_b64_tr_b16 v[20:21], v2 offset:8192
    ds_read_b64_tr_b16 v[22:23], v2 offset:8704
    ds_read_b64_tr_b16 v[24:25], v2 offset:16384
    ds_read_b64_tr_b16 v[26:27], v2 offset:16896
    ds_read_b64_tr_b16 v[28:29], v2 offset:1024
    ds_read_b64_tr_b16 v[30:31], v2 offset:1536
    ds_read_b64_tr_b16 v[32:33], v2 offset:9216
    ds_read_b64_tr_b16 v[34:35], v2 offset:9728
    ds_read_b64_tr_b16 v[36:37], v2 offset:17408
    ds_read_b64_tr_b16 v[38:39], v2 offset:17920
    s_waitcnt lgkmcnt(6)
    v_lshlrev_b32 v40, 16, v16
    v_and_b32 v41, s72, v16
    v_lshlrev_b32 v44, 16, v24
    v_and_b32 v45, s72, v24
    v_lshlrev_b32 v42, 16, v20
    v_and_b32 v43, s72, v20
    v_add_f32 v40, v40, v44
    v_add_f32 v41, v41, v45
    v_add_f32 v46, v40, v42 div:2
    v_add_f32 v47, v41, v43 div:2
    v_sub_f32 v48, v40, v42 div:2
    v_sub_f32 v49, v41, v43 div:2
    v_cvt_pk_bf16_f32 v64, v46, v47
    v_cvt_pk_bf16_f32 v68, v48, v49
    v_lshlrev_b32 v40, 16, v17
    v_and_b32 v41, s72, v17
    v_lshlrev_b32 v44, 16, v25
    v_and_b32 v45, s72, v25
    v_lshlrev_b32 v42, 16, v21
    v_and_b32 v43, s72, v21
    v_add_f32 v40, v40, v44
    v_add_f32 v41, v41, v45
    v_add_f32 v46, v40, v42 div:2
    v_add_f32 v47, v41, v43 div:2
    v_sub_f32 v48, v40, v42 div:2
    v_sub_f32 v49, v41, v43 div:2
    v_cvt_pk_bf16_f32 v65, v46, v47
    v_cvt_pk_bf16_f32 v69, v48, v49
    v_lshlrev_b32 v40, 16, v18
    v_and_b32 v41, s72, v18
    v_lshlrev_b32 v44, 16, v26
    v_and_b32 v45, s72, v26
    v_lshlrev_b32 v42, 16, v22
    v_and_b32 v43, s72, v22
    v_add_f32 v40, v40, v44
    v_add_f32 v41, v41, v45
    v_add_f32 v46, v40, v42 div:2
    v_add_f32 v47, v41, v43 div:2
    v_sub_f32 v48, v40, v42 div:2
    v_sub_f32 v49, v41, v43 div:2
    v_cvt_pk_bf16_f32 v66, v46, v47
    v_cvt_pk_bf16_f32 v70, v48, v49
    v_lshlrev_b32 v40, 16, v19
    v_and_b32 v41, s72, v19
    v_lshlrev_b32 v44, 16, v27
    v_and_b32 v45, s72, v27
    v_lshlrev_b32 v42, 16, v23
    v_and_b32 v43, s72, v23
    v_add_f32 v40, v40, v44
    v_add_f32 v41, v41, v45
    v_add_f32 v46, v40, v42 div:2
    v_add_f32 v47, v41, v43 div:2
    v_sub_f32 v48, v40, v42 div:2
    v_sub_f32 v49, v41, v43 div:2
    v_cvt_pk_bf16_f32 v67, v46, v47
    v_cvt_pk_bf16_f32 v71, v48, v49
    s_add_u32 s99, s70, 0
    buffer_store_dwordx4 v[68:71], v7, s[20:23], s99 offen sc1
    s_add_u32 s99, s70, 73728
    buffer_store_dwordx4 v[64:67], v7, s[20:23], s99 offen sc1
    s_add_u32 s99, s71, 589824
    buffer_store_dwordx4 v[24:27], v7, s[20:23], s99 offen sc1
    s_cmp_eq_u32 s92, 0
    s_cbranch_scc1 L_nos0
    s_add_u32 s99, s71, 368640
    buffer_store_dwordx4 v[16:19], v7, s[20:23], s99 offen sc1
L_nos0:
    s_waitcnt lgkmcnt(0)
    v_lshlrev_b32 v40, 16, v28
    v_and_b32 v41, s72, v28
    v_lshlrev_b32 v44, 16, v36
    v_and_b32 v45, s72, v36
    v_lshlrev_b32 v42, 16, v32
    v_and_b32 v43, s72, v32
    v_add_f32 v40, v40, v44
    v_add_f32 v41, v41, v45
    v_add_f32 v46, v40, v42 div:2
    v_add_f32 v47, v41, v43 div:2
    v_sub_f32 v48, v40, v42 div:2
    v_sub_f32 v49, v41, v43 div:2
    v_cvt_pk_bf16_f32 v80, v46, v47
    v_cvt_pk_bf16_f32 v84, v48, v49
    v_lshlrev_b32 v40, 16, v29
    v_and_b32 v41, s72, v29
    v_lshlrev_b32 v44, 16, v37
    v_and_b32 v45, s72, v37
    v_lshlrev_b32 v42, 16, v33
    v_and_b32 v43, s72, v33
    v_add_f32 v40, v40, v44
    v_add_f32 v41, v41, v45
    v_add_f32 v46, v40, v42 div:2
    v_add_f32 v47, v41, v43 div:2
    v_sub_f32 v48, v40, v42 div:2
    v_sub_f32 v49, v41, v43 div:2
    v_cvt_pk_bf16_f32 v81, v46, v47
    v_cvt_pk_bf16_f32 v85, v48, v49
    v_lshlrev_b32 v40, 16, v30
    v_and_b32 v41, s72, v30
    v_lshlrev_b32 v44, 16, v38
    v_and_b32 v45, s72, v38
    v_lshlrev_b32 v42, 16, v34
    v_and_b32 v43, s72, v34
    v_add_f32 v40, v40, v44
    v_add_f32 v41, v41, v45
    v_add_f32 v46, v40, v42 div:2
    v_add_f32 v47, v41, v43 div:2
    v_sub_f32 v48, v40, v42 div:2
    v_sub_f32 v49, v41, v43 div:2
    v_cvt_pk_bf16_f32 v82, v46, v47
    v_cvt_pk_bf16_f32 v86, v48, v49
    v_lshlrev_b32 v40, 16, v31
    v_and_b32 v41, s72, v31
    v_lshlrev_b32 v44, 16, v39
    v_and_b32 v45, s72, v39
    v_lshlrev_b32 v42, 16, v35
    v_and_b32 v43, s72, v35
    v_add_f32 v40, v40, v44
    v_add_f32 v41, v41, v45
    v_add_f32 v46, v40, v42 div:2
    v_add_f32 v47, v41, v43 div:2
    v_sub_f32 v48, v40, v42 div:2
    v_sub_f32 v49, v41, v43 div:2
    v_cvt_pk_bf16_f32 v83, v46, v47
    v_cvt_pk_bf16_f32 v87, v48, v49
    s_add_u32 s99, s70, 12288
    buffer_store_dwordx4 v[84:87], v7, s[20:23], s99 offen sc1
    s_add_u32 s99, s70, 86016
    buffer_store_dwordx4 v[80:83], v7, s[20:23], s99 offen sc1
    s_add_u32 s99, s71, 602112
    buffer_store_dwordx4 v[36:39], v7, s[20:23], s99 offen sc1
    s_cmp_eq_u32 s92, 0
    s_cbranch_scc1 L_nos1
    s_add_u32 s99, s71, 380928
    buffer_store_dwordx4 v[28:31], v7, s[20:23], s99 offen sc1
L_nos1:
    s_waitcnt vmcnt(0)
    s_barrier
    s_cmp_eq_u32 s28, 0
    s_cbranch_scc0 L_xpfbar
    v_cmp_eq_u32 vcc, 0, v0
    s_and_saveexec_b64 s[96:97], vcc
    s_cbranch_execz L_nogo
    s_lshl_b32 s3, s92, 2
    v_mov_b32 v1, s3
    v_mov_b32 v2, 1
    global_atomic_add v3, v1, v2, s[10:11] sc0
    s_waitcnt vmcnt(0)
    v_readfirstlane_b32 s3, v3
    s_nop 3
    s_cmp_eq_u32 s3, 8
    s_cbranch_scc0 L_nogo
    global_store_dword v1, v2, s[10:11] offset:128 sc1
L_nogo:
    s_mov_b64 exec, -1
    s_waitcnt vmcnt(0)
L_xpfbar:
    s_barrier
    s_branch L_xpf
L_idle:
    s_waitcnt lgkmcnt(0)
L_xpf:
    s_and_b32 s92, s2, 7
    s_lshr_b32 s93, s2, 3
    s_lshl_b32 s93, s93, 2
    s_add_u32 s93, s93, s28
    s_and_b32 s94, s92, 3
    s_mul_i32 s94, s94, 28
    s_lshl_b32 s95, s93, 1
    s_add_u32 s94, s94, s95
    s_sub_u32 s94, s94, 1
    s_lshr_b32 s95, s92, 2
    s_mov_b32 s16, s4
    s_mov_b32 s17, s5
    s_mov_b32 s18, 19267584
    s_mov_b32 s19, 0x20000
    v_mul_u32_u24 v1, 384, v0
    v_add_u32 v2, 24576, v1
    v_add_u32 v3, 24576, v2
    v_add_u32 v4, 24576, v3
    v_bfrev_b32 v5, 1
    v_cmp_gt_u32 vcc, 32, v0
    s_nop 1
    v_cndmask_b32 v4, v5, v4, vcc
    s_add_u32 s96, s94, 0
    s_cmp_lt_u32 s96, 112
    s_cbranch_scc0 L_xpf1_0
    s_lshl_b32 s96, s96, 1
    s_add_u32 s96, s96, s95
    s_mul_i32 s96, s96, 86016
    s_add_u32 s97, s96, 128
    buffer_load_dword v10, v1, s[16:19], s97 offen
    buffer_load_dword v11, v2, s[16:19], s97 offen
    buffer_load_dword v12, v3, s[16:19], s97 offen
    buffer_load_dword v13, v4, s[16:19], s97 offen
L_xpf1_0:
    s_add_u32 s96, s94, 1
    s_cmp_lt_u32 s96, 112
    s_cbranch_scc0 L_xpf1_1
    s_lshl_b32 s96, s96, 1
    s_add_u32 s96, s96, s95
    s_mul_i32 s96, s96, 86016
    s_add_u32 s97, s96, 128
    buffer_load_dword v10, v1, s[16:19], s97 offen
    buffer_load_dword v11, v2, s[16:19], s97 offen
    buffer_load_dword v12, v3, s[16:19], s97 offen
    buffer_load_dword v13, v4, s[16:19], s97 offen
L_xpf1_1:
    s_add_u32 s96, s94, 0
    s_cmp_lt_u32 s96, 112
    s_cbranch_scc0 L_xpf2_0
    s_lshl_b32 s96, s96, 1
    s_add_u32 s96, s96, s95
    s_mul_i32 s96, s96, 86016
    s_add_u32 s97, s96, 256
    buffer_load_dword v10, v1, s[16:19], s97 offen
    buffer_load_dword v11, v2, s[16:19], s97 offen
    buffer_load_dword v12, v3, s[16:19], s97 offen
    buffer_load_dword v13, v4, s[16:19], s97 offen
L_xpf2_0:
    s_add_u32 s96, s94, 1
    s_cmp_lt_u32 s96, 112
    s_cbranch_scc0 L_xpf2_1
    s_lshl_b32 s96, s96, 1
    s_add_u32 s96, s96, s95
    s_mul_i32 s96, s96, 86016
    s_add_u32 s97, s96, 256
    buffer_load_dword v10, v1, s[16:19], s97 offen
    buffer_load_dword v11, v2, s[16:19], s97 offen
    buffer_load_dword v12, v3, s[16:19], s97 offen
    buffer_load_dword v13, v4, s[16:19], s97 offen
L_xpf2_1:
    s_waitcnt vmcnt(0)
L_end:
    s_endpgm
.p2align 12
L_main:
L_pad0:
    s_cbranch_vccnz L_pad1
    s_waitcnt lgkmcnt(4)
    v_mfma_f32_16x16x32_bf16 v[84:87], a[32:35], a[0:3], 0
    ds_read_b128 a[28:31], v11 offset:0
    s_add_u32 s34, s39, 147456
    v_mfma_f32_16x16x32_bf16 v[88:91], a[36:39], a[0:3], 0
    s_add_u32 m0, s3, 49152
    ds_read_b128 v[32:35], v22 offset:18432
    v_mfma_f32_16x16x32_bf16 v[92:95], a[40:43], a[0:3], 0
    buffer_load_dwordx4 v77, s[4:7], s34 offen offset:0 lds
    v_mfma_f32_16x16x32_bf16 v[96:99], a[32:35], a[4:7], 0
    ds_read_b128 a[0:3], v11 offset:2304
    ds_read_b128 v[36:39], v22 offset:2304
    v_mfma_f32_16x16x32_bf16 v[100:103], a[36:39], a[4:7], 0
    buffer_load_dwordx4 v77, s[4:7], s34 offen offset:1024 lds
    v_mfma_f32_16x16x32_bf16 v[104:107], a[40:43], a[4:7], 0
    ds_read_b128 v[40:43], v23 offset:18432
    ds_read_b128 v[44:47], v23 offset:2304
    v_mfma_f32_16x16x32_bf16 v[108:111], a[32:35], a[8:11], 0
    ds_read_b128 a[4:7], v11 offset:4608
    v_mfma_f32_16x16x32_bf16 v[112:115], a[36:39], a[8:11], 0
    buffer_load_dwordx4 v77, s[4:7], s34 offen offset:2048 lds
    s_add_u32 s34, s39, 150528
    v_mfma_f32_16x16x32_bf16 v[116:119], a[40:43], a[8:11], 0
    s_add_u32 m0, s3, 61440
    s_waitcnt vmcnt(6)
    s_barrier
    s_waitcnt lgkmcnt(8)
    v_mfma_f32_16x16x32_bf16 v[120:123], a[32:35], a[12:15], 0
    ds_read_b128 a[8:11], v11 offset:6912
    ds_read_b64_tr_b16 a[44:45], v78 offset:12288
    v_mfma_f32_16x16x32_bf16 v[124:127], a[36:39], a[12:15], 0
    ds_read_b64_tr_b16 a[48:49], v78 offset:12296
    ds_read_b64_tr_b16 a[52:53], v76 offset:12288
    ds_read_b64_tr_b16 a[46:47], v78 offset:13824
    v_mfma_f32_16x16x32_bf16 v[128:131], a[40:43], a[12:15], 0
    ds_read_b64_tr_b16 a[50:51], v78 offset:13832
    ds_read_b64_tr_b16 a[54:55], v76 offset:13824
    v_mfma_f32_16x16x32_bf16 v[132:135], a[32:35], a[16:19], 0
    s_waitcnt lgkmcnt(13)
    ds_read_b128 a[12:15], v11 offset:9216
    v_mfma_f32_16x16x32_bf16 v[136:139], a[36:39], a[16:19], 0
    buffer_load_dwordx4 v77, s[4:7], s34 offen offset:0 lds
    v_mfma_f32_16x16x32_bf16 v[140:143], a[40:43], a[16:19], 0
    v_mfma_f32_16x16x32_bf16 v[144:147], a[32:35], a[20:23], 0
    ds_read_b128 a[16:19], v11 offset:11520
    v_mfma_f32_16x16x32_bf16 v[148:151], a[36:39], a[20:23], 0
    global_load_dword v0, v31, s[10:11] offset:-4 sc1
    v_mfma_f32_16x16x32_bf16 v[152:155], a[40:43], a[20:23], 0
    s_waitcnt lgkmcnt(12)
    v_lshlrev_b32 v48, 16, v32
    v_mfma_f32_16x16x32_bf16 v[156:159], a[32:35], a[24:27], 0
    ds_read_b128 a[20:23], v11 offset:13824
    v_lshlrev_b32 v49, 16, v36
    v_mfma_f32_16x16x32_bf16 v[160:163], a[36:39], a[24:27], 0
    buffer_load_dwordx4 v77, s[4:7], s34 offen offset:1024 lds
    v_and_b32 v50, s36, v32
    v_mfma_f32_16x16x32_bf16 v[164:167], a[40:43], a[24:27], 0
    v_and_b32 v51, s36, v36
    s_waitcnt lgkmcnt(3)
    v_mfma_f32_16x16x32_bf16 v[84:87], a[44:47], a[28:31], v[84:87]
    ds_read_b128 a[24:27], v12 offset:0
    ds_read_b64_tr_b16 a[56:57], v78 offset:24576
    v_mfma_f32_16x16x32_bf16 v[88:91], a[48:51], a[28:31], v[88:91]
    ds_read_b64_tr_b16 a[60:61], v78 offset:24584
    ds_read_b64_tr_b16 a[64:65], v76 offset:24576
    ds_read_b64_tr_b16 a[58:59], v78 offset:26112
    v_mfma_f32_16x16x32_bf16 v[92:95], a[52:55], a[28:31], v[92:95]
    ds_read_b64_tr_b16 a[62:63], v78 offset:26120
    ds_read_b64_tr_b16 a[66:67], v76 offset:26112
    v_mfma_f32_16x16x32_bf16 v[96:99], a[44:47], a[0:3], v[96:99]
    ds_read_b128 a[28:31], v12 offset:2304
    v_lshlrev_b32 v80, 16, v33
    v_mfma_f32_16x16x32_bf16 v[100:103], a[48:51], a[0:3], v[100:103]
    buffer_load_dwordx4 v77, s[4:7], s34 offen offset:2048 lds
    v_lshlrev_b32 v81, 16, v37
    v_mfma_f32_16x16x32_bf16 v[104:107], a[52:55], a[0:3], v[104:107]
    v_and_b32 v82, s36, v33
    v_and_b32 v83, s36, v37
    v_mfma_f32_16x16x32_bf16 v[108:111], a[44:47], a[4:7], v[108:111]
    ds_read_b128 a[0:3], v12 offset:4608
    v_add_f32 v68, v48, v49
    v_mfma_f32_16x16x32_bf16 v[112:115], a[48:51], a[4:7], v[112:115]
    v_add_f32 v52, v50, v51
    v_sub_f32 v48, v49, v48
    v_sub_f32 v50, v51, v50
    v_mfma_f32_16x16x32_bf16 v[116:119], a[52:55], a[4:7], v[116:119]
    v_add_f32 v69, v80, v81
    v_add_f32 v53, v82, v83
    v_mfma_f32_16x16x32_bf16 v[120:123], a[44:47], a[8:11], v[120:123]
    ds_read_b128 a[4:7], v12 offset:6912
    v_sub_f32 v80, v81, v80
    v_mfma_f32_16x16x32_bf16 v[124:127], a[48:51], a[8:11], v[124:127]
    v_sub_f32 v82, v83, v82
    v_cvt_pk_bf16_f32 v68, v68, v52
    v_cvt_pk_bf16_f32 v52, v48, v50
    v_mfma_f32_16x16x32_bf16 v[128:131], a[52:55], a[8:11], v[128:131]
    v_lshlrev_b32 v48, 16, v34
    s_waitcnt lgkmcnt(10)
    v_mfma_f32_16x16x32_bf16 v[132:135], a[44:47], a[12:15], v[132:135]
    ds_read_b128 a[8:11], v12 offset:9216
    v_lshlrev_b32 v49, 16, v38
    v_mfma_f32_16x16x32_bf16 v[136:139], a[48:51], a[12:15], v[136:139]
    v_and_b32 v50, s36, v34
    v_and_b32 v51, s36, v38
    v_cvt_pk_bf16_f32 v69, v69, v53
    v_mfma_f32_16x16x32_bf16 v[140:143], a[52:55], a[12:15], v[140:143]
    v_cvt_pk_bf16_f32 v53, v80, v82
    v_lshlrev_b32 v80, 16, v35
    v_mfma_f32_16x16x32_bf16 v[144:147], a[44:47], a[16:19], v[144:147]
    ds_read_b128 a[12:15], v12 offset:11520
    v_lshlrev_b32 v81, 16, v39
    v_mfma_f32_16x16x32_bf16 v[148:151], a[48:51], a[16:19], v[148:151]
    v_and_b32 v82, s36, v35
    v_and_b32 v83, s36, v39
    v_add_f32 v70, v48, v49
    v_mfma_f32_16x16x32_bf16 v[152:155], a[52:55], a[16:19], v[152:155]
    v_add_f32 v54, v50, v51
    v_sub_f32 v48, v49, v48
    v_mfma_f32_16x16x32_bf16 v[156:159], a[44:47], a[20:23], v[156:159]
    ds_read_b128 a[16:19], v12 offset:13824
    v_sub_f32 v50, v51, v50
    v_mfma_f32_16x16x32_bf16 v[160:163], a[48:51], a[20:23], v[160:163]
    v_add_f32 v71, v80, v81
    v_add_f32 v55, v82, v83
    v_sub_f32 v80, v81, v80
    v_mfma_f32_16x16x32_bf16 v[164:167], a[52:55], a[20:23], v[164:167]
    s_waitcnt vmcnt(7)
    s_waitcnt lgkmcnt(6)
    s_barrier
    v_mfma_f32_16x16x32_bf16 v[84:87], a[56:59], a[24:27], v[84:87]
    ds_read_b128 a[20:23], v13 offset:0
    ds_read_b64_tr_b16 a[68:69], v78 offset:36864
    v_mfma_f32_16x16x32_bf16 v[88:91], a[60:63], a[24:27], v[88:91]
    ds_read_b64_tr_b16 a[72:73], v78 offset:36872
    ds_read_b64_tr_b16 a[76:77], v76 offset:36864
    ds_read_b64_tr_b16 a[70:71], v78 offset:38400
    v_mfma_f32_16x16x32_bf16 v[92:95], a[64:67], a[24:27], v[92:95]
    ds_read_b64_tr_b16 a[74:75], v78 offset:38408
    s_waitcnt lgkmcnt(9)
    v_mfma_f32_16x16x32_bf16 v[96:99], a[56:59], a[28:31], v[96:99]
    ds_read_b128 a[24:27], v13 offset:2304
    ds_read_b64_tr_b16 a[78:79], v76 offset:38400
    v_mfma_f32_16x16x32_bf16 v[100:103], a[60:63], a[28:31], v[100:103]
    s_add_u32 m0, s35, 36864
    v_sub_f32 v82, v83, v82
    v_cvt_pk_bf16_f32 v70, v70, v54
    v_mfma_f32_16x16x32_bf16 v[104:107], a[64:67], a[28:31], v[104:107]
    buffer_load_dwordx4 v1, s[16:19], s32 offen lds
    v_mfma_f32_16x16x32_bf16 v[108:111], a[56:59], a[0:3], v[108:111]
    ds_read_b128 a[28:31], v13 offset:4608
    s_add_u32 m0, s35, 40960
    v_mfma_f32_16x16x32_bf16 v[112:115], a[60:63], a[0:3], v[112:115]
    buffer_load_dwordx4 v2, s[16:19], s32 offen lds
    s_add_u32 m0, s35, 45056
    v_mfma_f32_16x16x32_bf16 v[116:119], a[64:67], a[0:3], v[116:119]
    v_cvt_pk_bf16_f32 v54, v48, v50
    v_cvt_pk_bf16_f32 v71, v71, v55
    v_mfma_f32_16x16x32_bf16 v[120:123], a[56:59], a[4:7], v[120:123]
    ds_read_b128 a[0:3], v13 offset:6912
    v_cvt_pk_bf16_f32 v55, v80, v82
    v_mfma_f32_16x16x32_bf16 v[124:127], a[60:63], a[4:7], v[124:127]
    buffer_load_dwordx4 v3, s[16:19], s32 offen lds
    v_mfma_f32_16x16x32_bf16 v[128:131], a[64:67], a[4:7], v[128:131]
    s_waitcnt lgkmcnt(10)
    v_mfma_f32_16x16x32_bf16 v[132:135], a[56:59], a[8:11], v[132:135]
    ds_read_b128 a[4:7], v13 offset:9216
    s_add_u32 m0, s35, 49152
    v_mfma_f32_16x16x32_bf16 v[136:139], a[60:63], a[8:11], v[136:139]
    buffer_load_dwordx4 v4, s[16:19], s32 offen lds
    s_add_u32 m0, s35, 53248
    v_mfma_f32_16x16x32_bf16 v[140:143], a[64:67], a[8:11], v[140:143]
    ds_write_b64 v18, v[52:53] offset:16384
    v_mfma_f32_16x16x32_bf16 v[144:147], a[56:59], a[12:15], v[144:147]
    ds_read_b128 a[8:11], v13 offset:11520
    buffer_load_dwordx4 v5, s[16:19], s32 offen lds
    v_mfma_f32_16x16x32_bf16 v[148:151], a[60:63], a[12:15], v[148:151]
    s_add_u32 m0, s35, 57344
    ds_write_b64 v18, v[54:55] offset:16392
    v_mfma_f32_16x16x32_bf16 v[152:155], a[64:67], a[12:15], v[152:155]
    buffer_load_dwordx4 v6, s[16:19], s32 offen lds
    v_mfma_f32_16x16x32_bf16 v[156:159], a[56:59], a[16:19], v[156:159]
    ds_read_b128 a[12:15], v13 offset:13824
    v_lshlrev_b32 v48, 16, v40
    v_lshlrev_b32 v49, 16, v44
    v_mfma_f32_16x16x32_bf16 v[160:163], a[60:63], a[16:19], v[160:163]
    v_and_b32 v50, s36, v40
    v_and_b32 v51, s36, v44
    v_lshlrev_b32 v80, 16, v41
    v_mfma_f32_16x16x32_bf16 v[164:167], a[64:67], a[16:19], v[164:167]
    s_waitcnt vmcnt(6)
    s_barrier
    s_waitcnt lgkmcnt(7)
    v_mfma_f32_16x16x32_bf16 v[84:87], a[68:71], a[20:23], v[84:87]
    ds_read_b128 a[16:19], v14 offset:0
    ds_read_b64_tr_b16 a[80:81], v78 offset:49152
    ds_read_b64_tr_b16 a[84:85], v78 offset:49160
    v_mfma_f32_16x16x32_bf16 v[88:91], a[72:75], a[20:23], v[88:91]
    ds_read_b64_tr_b16 a[88:89], v76 offset:49152
    ds_read_b64_tr_b16 a[82:83], v78 offset:50688
    ds_read_b64_tr_b16 a[86:87], v78 offset:50696
    v_mfma_f32_16x16x32_bf16 v[92:95], a[76:79], a[20:23], v[92:95]
    ds_read_b64_tr_b16 a[90:91], v76 offset:50688
    v_lshlrev_b32 v81, 16, v45
    v_and_b32 v82, s36, v41
    v_mfma_f32_16x16x32_bf16 v[96:99], a[68:71], a[24:27], v[96:99]
    ds_read_b128 a[20:23], v14 offset:2304
    s_add_u32 m0, s35, 61440
    v_and_b32 v83, s36, v45
    v_mfma_f32_16x16x32_bf16 v[100:103], a[72:75], a[24:27], v[100:103]
    buffer_load_dwordx4 v7, s[16:19], s32 offen lds
    s_add_u32 m0, s35, 65536
    v_mfma_f32_16x16x32_bf16 v[104:107], a[76:79], a[24:27], v[104:107]
    v_add_f32 v72, v48, v49
    v_add_f32 v56, v50, v51
    s_waitcnt lgkmcnt(12)
    v_mfma_f32_16x16x32_bf16 v[108:111], a[68:71], a[28:31], v[108:111]
    ds_read_b128 a[24:27], v14 offset:4608
    buffer_load_dwordx4 v8, s[16:19], s32 offen lds
    v_mfma_f32_16x16x32_bf16 v[112:115], a[72:75], a[28:31], v[112:115]
    s_add_u32 m0, s35, 69632
    v_sub_f32 v48, v49, v48
    v_sub_f32 v50, v51, v50
    v_mfma_f32_16x16x32_bf16 v[116:119], a[76:79], a[28:31], v[116:119]
    buffer_load_dwordx4 v9, s[16:19], s32 offen lds
    v_add_f32 v73, v80, v81
    v_mfma_f32_16x16x32_bf16 v[120:123], a[68:71], a[0:3], v[120:123]
    ds_read_b128 a[28:31], v14 offset:6912
    v_add_f32 v57, v82, v83
    v_sub_f32 v80, v81, v80
    v_mfma_f32_16x16x32_bf16 v[124:127], a[72:75], a[0:3], v[124:127]
    v_sub_f32 v82, v83, v82
    v_cvt_pk_bf16_f32 v72, v72, v56
    v_cvt_pk_bf16_f32 v56, v48, v50
    v_mfma_f32_16x16x32_bf16 v[128:131], a[76:79], a[0:3], v[128:131]
    v_lshlrev_b32 v48, 16, v42
    v_lshlrev_b32 v49, 16, v46
    v_mfma_f32_16x16x32_bf16 v[132:135], a[68:71], a[4:7], v[132:135]
    ds_read_b128 a[0:3], v14 offset:9216
    v_and_b32 v50, s36, v42
    v_and_b32 v51, s36, v46
    v_mfma_f32_16x16x32_bf16 v[136:139], a[72:75], a[4:7], v[136:139]
    v_cvt_pk_bf16_f32 v73, v73, v57
    v_cvt_pk_bf16_f32 v57, v80, v82
    v_lshlrev_b32 v80, 16, v43
    v_mfma_f32_16x16x32_bf16 v[140:143], a[76:79], a[4:7], v[140:143]
    v_lshlrev_b32 v81, 16, v47
    s_waitcnt lgkmcnt(10)
    v_mfma_f32_16x16x32_bf16 v[144:147], a[68:71], a[8:11], v[144:147]
    ds_read_b128 a[4:7], v14 offset:11520
    v_and_b32 v82, s36, v43
    v_mfma_f32_16x16x32_bf16 v[148:151], a[72:75], a[8:11], v[148:151]
    v_and_b32 v83, s36, v47
    v_add_f32 v74, v48, v49
    v_add_f32 v58, v50, v51
    v_mfma_f32_16x16x32_bf16 v[152:155], a[76:79], a[8:11], v[152:155]
    v_sub_f32 v48, v49, v48
    v_sub_f32 v50, v51, v50
    v_cmp_ne_u32 s[100:101], 0, v0
    s_cmp_eq_u32 s100, -1
    s_cbranch_scc0 L_slowflag
L_flagok:
    v_mfma_f32_16x16x32_bf16 v[156:159], a[68:71], a[12:15], v[156:159]
    ds_read_b128 a[8:11], v14 offset:13824
    v_add_f32 v75, v80, v81
    v_mfma_f32_16x16x32_bf16 v[160:163], a[72:75], a[12:15], v[160:163]
    v_add_f32 v59, v82, v83
    v_sub_f32 v80, v81, v80
    v_mfma_f32_16x16x32_bf16 v[164:167], a[76:79], a[12:15], v[164:167]
    v_sub_f32 v82, v83, v82
    s_waitcnt lgkmcnt(6)
    v_mfma_f32_16x16x32_bf16 v[84:87], a[80:83], a[16:19], v[84:87]
    ds_read_b128 a[12:15], v15 offset:0
    ds_read_b64_tr_b16 a[92:93], v78 offset:61440
    v_mfma_f32_16x16x32_bf16 v[88:91], a[84:87], a[16:19], v[88:91]
    ds_read_b64_tr_b16 a[96:97], v78 offset:61448
    ds_read_b64_tr_b16 a[100:101], v76 offset:61440
    v_mfma_f32_16x16x32_bf16 v[92:95], a[88:91], a[16:19], v[92:95]
    ds_read_b64_tr_b16 a[94:95], v78 offset:62976
    s_waitcnt lgkmcnt(8)
    v_mfma_f32_16x16x32_bf16 v[96:99], a[80:83], a[20:23], v[96:99]
    ds_read_b128 a[16:19], v15 offset:2304
    ds_read_b64_tr_b16 a[98:99], v78 offset:62984
    ds_read_b64_tr_b16 a[102:103], v76 offset:62976
    v_mfma_f32_16x16x32_bf16 v[100:103], a[84:87], a[20:23], v[100:103]
    s_mov_b32 s31, 0
    buffer_load_dwordx4 a[104:107], v28, s[20:23], s31 offen offset:0 sc1
    v_mfma_f32_16x16x32_bf16 v[104:107], a[88:91], a[20:23], v[104:107]
    v_cvt_pk_bf16_f32 v74, v74, v58
    v_cvt_pk_bf16_f32 v58, v48, v50
    v_cvt_pk_bf16_f32 v75, v75, v59
    v_mfma_f32_16x16x32_bf16 v[108:111], a[80:83], a[24:27], v[108:111]
    ds_read_b128 a[20:23], v15 offset:4608
    buffer_load_dwordx4 a[108:111], v28, s[20:23], s31 offen offset:1024 sc1
    v_cvt_pk_bf16_f32 v59, v80, v82
    v_mfma_f32_16x16x32_bf16 v[112:115], a[84:87], a[24:27], v[112:115]
    ds_write_b64 v19, v[56:57] offset:16384
    v_mfma_f32_16x16x32_bf16 v[116:119], a[88:91], a[24:27], v[116:119]
    buffer_load_dwordx4 a[112:115], v28, s[20:23], s31 offen offset:2048 sc1
    v_mfma_f32_16x16x32_bf16 v[120:123], a[80:83], a[28:31], v[120:123]
    ds_read_b128 a[24:27], v15 offset:6912
    s_mov_b32 s31, 12288
    v_mfma_f32_16x16x32_bf16 v[124:127], a[84:87], a[28:31], v[124:127]
    buffer_load_dwordx4 a[116:119], v28, s[20:23], s31 offen offset:0 sc1
    v_mfma_f32_16x16x32_bf16 v[128:131], a[88:91], a[28:31], v[128:131]
    ds_write_b64 v19, v[58:59] offset:16392
    s_waitcnt lgkmcnt(12)
    v_mfma_f32_16x16x32_bf16 v[132:135], a[80:83], a[0:3], v[132:135]
    ds_read_b128 a[28:31], v15 offset:9216
    v_mfma_f32_16x16x32_bf16 v[136:139], a[84:87], a[0:3], v[136:139]
    buffer_load_dwordx4 a[120:123], v28, s[20:23], s31 offen offset:1024 sc1
    v_mfma_f32_16x16x32_bf16 v[140:143], a[88:91], a[0:3], v[140:143]
    v_mfma_f32_16x16x32_bf16 v[144:147], a[80:83], a[4:7], v[144:147]
    ds_read_b128 a[0:3], v15 offset:11520
    v_mfma_f32_16x16x32_bf16 v[148:151], a[84:87], a[4:7], v[148:151]
    buffer_load_dwordx4 a[124:127], v28, s[20:23], s31 offen offset:2048 sc1
    v_mfma_f32_16x16x32_bf16 v[152:155], a[88:91], a[4:7], v[152:155]
    v_mfma_f32_16x16x32_bf16 v[156:159], a[80:83], a[8:11], v[156:159]
    ds_read_b128 a[4:7], v15 offset:13824
    v_mfma_f32_16x16x32_bf16 v[160:163], a[84:87], a[8:11], v[160:163]
    v_mfma_f32_16x16x32_bf16 v[164:167], a[88:91], a[8:11], v[164:167]
    s_waitcnt lgkmcnt(3)
    s_barrier
    v_mfma_f32_16x16x32_bf16 v[84:87], a[92:95], a[12:15], v[84:87]
    ds_read_b128 a[8:11], v10 offset:16384
    s_mov_b32 s31, 24576
    v_mfma_f32_16x16x32_bf16 v[88:91], a[96:99], a[12:15], v[88:91]
    buffer_load_dwordx4 a[128:131], v28, s[20:23], s31 offen offset:0 sc1
    v_mfma_f32_16x16x32_bf16 v[92:95], a[100:103], a[12:15], v[92:95]
    ds_write_b64 v16, v[60:61] offset:32768
    v_mfma_f32_16x16x32_bf16 v[96:99], a[92:95], a[16:19], v[96:99]
    ds_read_b128 a[12:15], v10 offset:18688
    v_mfma_f32_16x16x32_bf16 v[100:103], a[96:99], a[16:19], v[100:103]
    buffer_load_dwordx4 a[132:135], v28, s[20:23], s31 offen offset:1024 sc1
    v_mfma_f32_16x16x32_bf16 v[104:107], a[100:103], a[16:19], v[104:107]
    ds_write_b64 v16, v[62:63] offset:32776
    v_mfma_f32_16x16x32_bf16 v[108:111], a[92:95], a[20:23], v[108:111]
    ds_read_b128 a[16:19], v10 offset:20992
    v_mfma_f32_16x16x32_bf16 v[112:115], a[96:99], a[20:23], v[112:115]
    buffer_load_dwordx4 a[136:139], v28, s[20:23], s31 offen offset:2048 sc1
    v_mfma_f32_16x16x32_bf16 v[116:119], a[100:103], a[20:23], v[116:119]
    s_mov_b32 s31, 36864
    v_mfma_f32_16x16x32_bf16 v[120:123], a[92:95], a[24:27], v[120:123]
    ds_read_b128 a[20:23], v10 offset:23296
    v_mfma_f32_16x16x32_bf16 v[124:127], a[96:99], a[24:27], v[124:127]
    buffer_load_dwordx4 a[140:143], v28, s[20:23], s31 offen offset:0 sc1
    v_mfma_f32_16x16x32_bf16 v[128:131], a[100:103], a[24:27], v[128:131]
    s_waitcnt lgkmcnt(6)
    v_mfma_f32_16x16x32_bf16 v[132:135], a[92:95], a[28:31], v[132:135]
    ds_read_b128 a[24:27], v10 offset:25600
    v_mfma_f32_16x16x32_bf16 v[136:139], a[96:99], a[28:31], v[136:139]
    buffer_load_dwordx4 a[144:147], v28, s[20:23], s31 offen offset:1024 sc1
    v_mfma_f32_16x16x32_bf16 v[140:143], a[100:103], a[28:31], v[140:143]
    ds_write_b64 v17, v[64:65] offset:32768
    v_mfma_f32_16x16x32_bf16 v[144:147], a[92:95], a[0:3], v[144:147]
    ds_read_b128 a[28:31], v10 offset:27904
    v_mfma_f32_16x16x32_bf16 v[148:151], a[96:99], a[0:3], v[148:151]
    buffer_load_dwordx4 a[148:151], v28, s[20:23], s31 offen offset:2048 sc1
    v_mfma_f32_16x16x32_bf16 v[152:155], a[100:103], a[0:3], v[152:155]
    ds_write_b64 v17, v[66:67] offset:32776
    v_mfma_f32_16x16x32_bf16 v[156:159], a[92:95], a[4:7], v[156:159]
    ds_read_b128 a[0:3], v10 offset:30208
    v_mfma_f32_16x16x32_bf16 v[160:163], a[96:99], a[4:7], v[160:163]
    ds_write_b64 v18, v[68:69] offset:32768
    v_mfma_f32_16x16x32_bf16 v[164:167], a[100:103], a[4:7], v[164:167]
    s_waitcnt vmcnt(9)
    s_waitcnt lgkmcnt(7)
    v_mfma_f32_16x16x32_bf16 v[168:171], a[104:107], a[8:11], v[84:87]
    ds_read_b128 a[4:7], v11 offset:16384
    s_mov_b32 s31, 49152
    v_mfma_f32_16x16x32_bf16 v[172:175], a[108:111], a[8:11], v[88:91]
    buffer_load_dwordx4 a[152:155], v28, s[20:23], s31 offen offset:0 sc1
    v_mfma_f32_16x16x32_bf16 v[176:179], a[112:115], a[8:11], v[92:95]
    ds_write_b64 v18, v[70:71] offset:32776
    v_mfma_f32_16x16x32_bf16 v[180:183], a[104:107], a[12:15], v[96:99]
    ds_read_b128 a[8:11], v11 offset:18688
    v_mfma_f32_16x16x32_bf16 v[184:187], a[108:111], a[12:15], v[100:103]
    buffer_load_dwordx4 a[156:159], v28, s[20:23], s31 offen offset:1024 sc1
    v_mfma_f32_16x16x32_bf16 v[188:191], a[112:115], a[12:15], v[104:107]
    ds_write_b64 v19, v[72:73] offset:32768
    v_mfma_f32_16x16x32_bf16 v[192:195], a[104:107], a[16:19], v[108:111]
    ds_read_b128 a[12:15], v11 offset:20992
    v_mfma_f32_16x16x32_bf16 v[196:199], a[108:111], a[16:19], v[112:115]
    buffer_load_dwordx4 a[160:163], v28, s[20:23], s31 offen offset:2048 sc1
    v_mfma_f32_16x16x32_bf16 v[200:203], a[112:115], a[16:19], v[116:119]
    s_mov_b32 s31, 61440
    s_waitcnt lgkmcnt(8)
    v_mfma_f32_16x16x32_bf16 v[204:207], a[104:107], a[20:23], v[120:123]
    ds_read_b128 a[16:19], v11 offset:23296
    v_mfma_f32_16x16x32_bf16 v[208:211], a[108:111], a[20:23], v[124:127]
    buffer_load_dwordx4 a[164:167], v28, s[20:23], s31 offen offset:0 sc1
    v_mfma_f32_16x16x32_bf16 v[212:215], a[112:115], a[20:23], v[128:131]
    ds_write_b64 v19, v[74:75] offset:32776
    s_barrier
    v_mfma_f32_16x16x32_bf16 v[216:219], a[104:107], a[24:27], v[132:135]
    ds_read_b128 a[20:23], v11 offset:25600
    ds_read_b128 v[32:35], v20 offset:55296
    v_mfma_f32_16x16x32_bf16 v[220:223], a[108:111], a[24:27], v[136:139]
    buffer_load_dwordx4 a[168:171], v28, s[20:23], s31 offen offset:1024 sc1
    v_mfma_f32_16x16x32_bf16 v[224:227], a[112:115], a[24:27], v[140:143]
    ds_read_b128 v[36:39], v20 offset:39168
    ds_read_b128 v[40:43], v21 offset:55296
    v_mfma_f32_16x16x32_bf16 v[228:231], a[104:107], a[28:31], v[144:147]
    ds_read_b128 a[24:27], v11 offset:27904
    s_waitcnt lgkmcnt(13)
    ds_read_b128 v[44:47], v21 offset:39168
    v_mfma_f32_16x16x32_bf16 v[232:235], a[108:111], a[28:31], v[148:151]
    buffer_load_dwordx4 a[172:175], v28, s[20:23], s31 offen offset:2048 sc1
    v_mfma_f32_16x16x32_bf16 v[236:239], a[112:115], a[28:31], v[152:155]
    v_mfma_f32_16x16x32_bf16 v[240:243], a[104:107], a[0:3], v[156:159]
    ds_read_b128 a[28:31], v11 offset:30208
    v_mfma_f32_16x16x32_bf16 v[244:247], a[108:111], a[0:3], v[160:163]
    v_mfma_f32_16x16x32_bf16 v[248:251], a[112:115], a[0:3], v[164:167]
    s_waitcnt vmcnt(12)
    s_waitcnt lgkmcnt(9)
    v_mfma_f32_16x16x32_bf16 v[168:171], a[116:119], a[4:7], v[168:171]
    ds_read_b128 a[0:3], v12 offset:16384
    s_mov_b32 s31, 73728
    v_mfma_f32_16x16x32_bf16 v[172:175], a[120:123], a[4:7], v[172:175]
    buffer_load_dwordx4 a[176:179], v28, s[20:23], s31 offen offset:0 sc1
    v_mfma_f32_16x16x32_bf16 v[176:179], a[124:127], a[4:7], v[176:179]
    v_mfma_f32_16x16x32_bf16 v[180:183], a[116:119], a[8:11], v[180:183]
    ds_read_b128 a[4:7], v12 offset:18688
    v_mfma_f32_16x16x32_bf16 v[184:187], a[120:123], a[8:11], v[184:187]
    buffer_load_dwordx4 a[180:183], v28, s[20:23], s31 offen offset:1024 sc1
    v_mfma_f32_16x16x32_bf16 v[188:191], a[124:127], a[8:11], v[188:191]
    s_waitcnt lgkmcnt(6)
    v_lshlrev_b32 v48, 16, v32
    v_mfma_f32_16x16x32_bf16 v[192:195], a[116:119], a[12:15], v[192:195]
    ds_read_b128 a[8:11], v12 offset:20992
    v_lshlrev_b32 v49, 16, v36
    v_mfma_f32_16x16x32_bf16 v[196:199], a[120:123], a[12:15], v[196:199]
    buffer_load_dwordx4 a[184:187], v28, s[20:23], s31 offen offset:2048 sc1
    v_mfma_f32_16x16x32_bf16 v[200:203], a[124:127], a[12:15], v[200:203]
    v_and_b32 v50, s36, v32
    v_and_b32 v51, s36, v36
    v_mfma_f32_16x16x32_bf16 v[204:207], a[116:119], a[16:19], v[204:207]
    ds_read_b128 a[12:15], v12 offset:23296
    v_lshlrev_b32 v80, 16, v33
    v_mfma_f32_16x16x32_bf16 v[208:211], a[120:123], a[16:19], v[208:211]
    v_lshlrev_b32 v81, 16, v37
    v_and_b32 v82, s36, v33
    v_mfma_f32_16x16x32_bf16 v[212:215], a[124:127], a[16:19], v[212:215]
    v_and_b32 v83, s36, v37
    v_add_f32 v60, v48, v49
    v_mfma_f32_16x16x32_bf16 v[216:219], a[116:119], a[20:23], v[216:219]
    ds_read_b128 a[16:19], v12 offset:25600
    v_add_f32 v52, v50, v51
    v_mfma_f32_16x16x32_bf16 v[220:223], a[120:123], a[20:23], v[220:223]
    v_sub_f32 v48, v49, v48
    v_sub_f32 v50, v51, v50
    v_mfma_f32_16x16x32_bf16 v[224:227], a[124:127], a[20:23], v[224:227]
    v_add_f32 v61, v80, v81
    s_waitcnt lgkmcnt(4)
    v_mfma_f32_16x16x32_bf16 v[228:231], a[116:119], a[24:27], v[228:231]
    ds_read_b128 a[20:23], v12 offset:27904
    v_add_f32 v53, v82, v83
    v_mfma_f32_16x16x32_bf16 v[232:235], a[120:123], a[24:27], v[232:235]
    v_sub_f32 v80, v81, v80
    v_sub_f32 v82, v83, v82
    v_mfma_f32_16x16x32_bf16 v[236:239], a[124:127], a[24:27], v[236:239]
    v_cvt_pk_bf16_f32 v60, v60, v52
    v_cvt_pk_bf16_f32 v52, v48, v50
    v_mfma_f32_16x16x32_bf16 v[240:243], a[116:119], a[28:31], v[240:243]
    ds_read_b128 a[24:27], v12 offset:30208
    v_lshlrev_b32 v48, 16, v34
    v_mfma_f32_16x16x32_bf16 v[244:247], a[120:123], a[28:31], v[244:247]
    v_lshlrev_b32 v49, 16, v38
    v_and_b32 v50, s36, v34
    v_mfma_f32_16x16x32_bf16 v[248:251], a[124:127], a[28:31], v[248:251]
    v_and_b32 v51, s36, v38
    s_waitcnt vmcnt(12)
    v_mfma_f32_16x16x32_bf16 v[168:171], a[128:131], a[0:3], v[168:171]
    ds_read_b128 a[28:31], v13 offset:16384
    s_mov_b32 s31, 86016
    v_mfma_f32_16x16x32_bf16 v[172:175], a[132:135], a[0:3], v[172:175]
    buffer_load_dwordx4 a[188:191], v28, s[20:23], s31 offen offset:0 sc1
    v_mfma_f32_16x16x32_bf16 v[176:179], a[136:139], a[0:3], v[176:179]
    v_cvt_pk_bf16_f32 v61, v61, v53
    s_waitcnt lgkmcnt(4)
    v_mfma_f32_16x16x32_bf16 v[180:183], a[128:131], a[4:7], v[180:183]
    ds_read_b128 a[0:3], v13 offset:18688
    v_cvt_pk_bf16_f32 v53, v80, v82
    v_mfma_f32_16x16x32_bf16 v[184:187], a[132:135], a[4:7], v[184:187]
    buffer_load_dwordx4 a[192:195], v28, s[20:23], s31 offen offset:1024 sc1
    v_mfma_f32_16x16x32_bf16 v[188:191], a[136:139], a[4:7], v[188:191]
    v_lshlrev_b32 v80, 16, v35
    v_lshlrev_b32 v81, 16, v39
    v_mfma_f32_16x16x32_bf16 v[192:195], a[128:131], a[8:11], v[192:195]
    ds_read_b128 a[4:7], v13 offset:20992
    v_and_b32 v82, s36, v35
    v_mfma_f32_16x16x32_bf16 v[196:199], a[132:135], a[8:11], v[196:199]
    buffer_load_dwordx4 a[196:199], v28, s[20:23], s31 offen offset:2048 sc1
    v_mfma_f32_16x16x32_bf16 v[200:203], a[136:139], a[8:11], v[200:203]
    v_and_b32 v83, s36, v39
    v_add_f32 v62, v48, v49
    v_mfma_f32_16x16x32_bf16 v[204:207], a[128:131], a[12:15], v[204:207]
    ds_read_b128 a[8:11], v13 offset:23296
    v_add_f32 v54, v50, v51
    v_mfma_f32_16x16x32_bf16 v[208:211], a[132:135], a[12:15], v[208:211]
    v_sub_f32 v48, v49, v48
    v_sub_f32 v50, v51, v50
    v_mfma_f32_16x16x32_bf16 v[212:215], a[136:139], a[12:15], v[212:215]
    v_add_f32 v63, v80, v81
    s_waitcnt lgkmcnt(4)
    v_mfma_f32_16x16x32_bf16 v[216:219], a[128:131], a[16:19], v[216:219]
    ds_read_b128 a[12:15], v13 offset:25600
    s_add_u32 m0, s35, 73728
    v_mfma_f32_16x16x32_bf16 v[220:223], a[132:135], a[16:19], v[220:223]
    global_load_dword v0, v31, s[10:11] sc1
    v_mfma_f32_16x16x32_bf16 v[224:227], a[136:139], a[16:19], v[224:227]
    v_add_f32 v55, v82, v83
    v_sub_f32 v80, v81, v80
    v_mfma_f32_16x16x32_bf16 v[228:231], a[128:131], a[20:23], v[228:231]
    ds_read_b128 a[16:19], v13 offset:27904
    v_sub_f32 v82, v83, v82
    v_mfma_f32_16x16x32_bf16 v[232:235], a[132:135], a[20:23], v[232:235]
    buffer_load_dwordx4 v1, s[16:19], s33 offen lds
    v_mfma_f32_16x16x32_bf16 v[236:239], a[136:139], a[20:23], v[236:239]
    s_add_u32 m0, s35, 77824
    v_cvt_pk_bf16_f32 v62, v62, v54
    v_mfma_f32_16x16x32_bf16 v[240:243], a[128:131], a[24:27], v[240:243]
    ds_read_b128 a[20:23], v13 offset:30208
    v_cvt_pk_bf16_f32 v54, v48, v50
    v_mfma_f32_16x16x32_bf16 v[244:247], a[132:135], a[24:27], v[244:247]
    buffer_load_dwordx4 v2, s[16:19], s33 offen lds
    v_mfma_f32_16x16x32_bf16 v[248:251], a[136:139], a[24:27], v[248:251]
    s_waitcnt vmcnt(15)
    s_waitcnt lgkmcnt(4)
    v_mfma_f32_16x16x32_bf16 v[168:171], a[140:143], a[28:31], v[168:171]
    ds_read_b128 a[24:27], v14 offset:16384
    s_mov_b32 s31, 98304
    v_mfma_f32_16x16x32_bf16 v[172:175], a[144:147], a[28:31], v[172:175]
    buffer_load_dwordx4 a[200:203], v28, s[20:23], s31 offen offset:0 sc1
    v_mfma_f32_16x16x32_bf16 v[176:179], a[148:151], a[28:31], v[176:179]
    s_add_u32 m0, s35, 81920
    v_cvt_pk_bf16_f32 v63, v63, v55
    v_mfma_f32_16x16x32_bf16 v[180:183], a[140:143], a[0:3], v[180:183]
    ds_read_b128 a[28:31], v14 offset:18688
    v_cvt_pk_bf16_f32 v55, v80, v82
    v_mfma_f32_16x16x32_bf16 v[184:187], a[144:147], a[0:3], v[184:187]
    buffer_load_dwordx4 a[204:207], v28, s[20:23], s31 offen offset:1024 sc1
    v_mfma_f32_16x16x32_bf16 v[188:191], a[148:151], a[0:3], v[188:191]
    ds_read_b128 v[32:35], v22 offset:55296
    ds_read_b128 v[36:39], v22 offset:39168
    v_mfma_f32_16x16x32_bf16 v[192:195], a[140:143], a[4:7], v[192:195]
    ds_read_b128 a[0:3], v14 offset:20992
    v_lshlrev_b32 v48, 16, v40
    v_mfma_f32_16x16x32_bf16 v[196:199], a[144:147], a[4:7], v[196:199]
    buffer_load_dwordx4 a[208:211], v28, s[20:23], s31 offen offset:2048 sc1
    v_mfma_f32_16x16x32_bf16 v[200:203], a[148:151], a[4:7], v[200:203]
    v_lshlrev_b32 v49, 16, v44
    s_waitcnt lgkmcnt(6)
    v_mfma_f32_16x16x32_bf16 v[204:207], a[140:143], a[8:11], v[204:207]
    ds_read_b128 a[4:7], v14 offset:23296
    v_and_b32 v50, s36, v40
    v_mfma_f32_16x16x32_bf16 v[208:211], a[144:147], a[8:11], v[208:211]
    buffer_load_dwordx4 v3, s[16:19], s33 offen lds
    v_mfma_f32_16x16x32_bf16 v[212:215], a[148:151], a[8:11], v[212:215]
    s_add_u32 m0, s35, 86016
    v_and_b32 v51, s36, v44
    v_mfma_f32_16x16x32_bf16 v[216:219], a[140:143], a[12:15], v[216:219]
    ds_read_b128 a[8:11], v14 offset:25600
    v_lshlrev_b32 v80, 16, v41
    v_mfma_f32_16x16x32_bf16 v[220:223], a[144:147], a[12:15], v[220:223]
    buffer_load_dwordx4 v4, s[16:19], s33 offen lds
    v_mfma_f32_16x16x32_bf16 v[224:227], a[148:151], a[12:15], v[224:227]
    s_add_u32 m0, s35, 90112
    v_lshlrev_b32 v81, 16, v45
    v_mfma_f32_16x16x32_bf16 v[228:231], a[140:143], a[16:19], v[228:231]
    ds_read_b128 a[12:15], v14 offset:27904
    v_and_b32 v82, s36, v41
    v_mfma_f32_16x16x32_bf16 v[232:235], a[144:147], a[16:19], v[232:235]
    buffer_load_dwordx4 v5, s[16:19], s33 offen lds
    v_mfma_f32_16x16x32_bf16 v[236:239], a[148:151], a[16:19], v[236:239]
    s_add_u32 m0, s35, 94208
    s_waitcnt lgkmcnt(6)
    v_mfma_f32_16x16x32_bf16 v[240:243], a[140:143], a[20:23], v[240:243]
    ds_read_b128 a[16:19], v14 offset:30208
    v_and_b32 v83, s36, v45
    v_mfma_f32_16x16x32_bf16 v[244:247], a[144:147], a[20:23], v[244:247]
    buffer_load_dwordx4 v6, s[16:19], s33 offen lds
    v_add_f32 v64, v48, v49
    v_mfma_f32_16x16x32_bf16 v[248:251], a[148:151], a[20:23], v[248:251]
    v_add_f32 v56, v50, v51
    s_waitcnt vmcnt(19)
    v_mfma_f32_16x16x32_bf16 v[168:171], a[152:155], a[24:27], v[168:171]
    ds_read_b128 a[20:23], v15 offset:16384
    s_mov_b32 s31, 110592
L_pad1:
    s_cbranch_vccnz L_pad2
    v_mfma_f32_16x16x32_bf16 v[172:175], a[156:159], a[24:27], v[172:175]
    buffer_load_dwordx4 a[212:215], v28, s[20:23], s31 offen offset:0 sc1
    v_sub_f32 v48, v49, v48
    v_mfma_f32_16x16x32_bf16 v[176:179], a[160:163], a[24:27], v[176:179]
    v_sub_f32 v50, v51, v50
    v_add_f32 v65, v80, v81
    v_mfma_f32_16x16x32_bf16 v[180:183], a[152:155], a[28:31], v[180:183]
    ds_read_b128 a[24:27], v15 offset:18688
    v_add_f32 v57, v82, v83
    v_mfma_f32_16x16x32_bf16 v[184:187], a[156:159], a[28:31], v[184:187]
    buffer_load_dwordx4 a[216:219], v28, s[20:23], s31 offen offset:1024 sc1
    v_sub_f32 v80, v81, v80
    v_mfma_f32_16x16x32_bf16 v[188:191], a[160:163], a[28:31], v[188:191]
    v_sub_f32 v82, v83, v82
    s_waitcnt lgkmcnt(4)
    v_mfma_f32_16x16x32_bf16 v[192:195], a[152:155], a[0:3], v[192:195]
    ds_read_b128 a[28:31], v15 offset:20992
    s_add_u32 m0, s35, 98304
    v_mfma_f32_16x16x32_bf16 v[196:199], a[156:159], a[0:3], v[196:199]
    buffer_load_dwordx4 a[220:223], v28, s[20:23], s31 offen offset:2048 sc1
    v_cvt_pk_bf16_f32 v64, v64, v56
    v_mfma_f32_16x16x32_bf16 v[200:203], a[160:163], a[0:3], v[200:203]
    v_cvt_pk_bf16_f32 v56, v48, v50
    v_lshlrev_b32 v48, 16, v42
    v_mfma_f32_16x16x32_bf16 v[204:207], a[152:155], a[4:7], v[204:207]
    ds_read_b128 a[0:3], v15 offset:23296
    v_lshlrev_b32 v49, 16, v46
    v_mfma_f32_16x16x32_bf16 v[208:211], a[156:159], a[4:7], v[208:211]
    buffer_load_dwordx4 v7, s[16:19], s33 offen lds
    s_add_u32 m0, s35, 102400
    v_mfma_f32_16x16x32_bf16 v[212:215], a[160:163], a[4:7], v[212:215]
    v_and_b32 v50, s36, v42
    v_and_b32 v51, s36, v46
    v_mfma_f32_16x16x32_bf16 v[216:219], a[152:155], a[8:11], v[216:219]
    ds_read_b128 a[4:7], v15 offset:25600
    v_cvt_pk_bf16_f32 v65, v65, v57
    v_mfma_f32_16x16x32_bf16 v[220:223], a[156:159], a[8:11], v[220:223]
    buffer_load_dwordx4 v8, s[16:19], s33 offen lds
    s_add_u32 m0, s35, 106496
    v_mfma_f32_16x16x32_bf16 v[224:227], a[160:163], a[8:11], v[224:227]
    v_cvt_pk_bf16_f32 v57, v80, v82
    s_waitcnt lgkmcnt(4)
    v_mfma_f32_16x16x32_bf16 v[228:231], a[152:155], a[12:15], v[228:231]
    ds_read_b128 a[8:11], v15 offset:27904
    v_lshlrev_b32 v80, 16, v43
    v_mfma_f32_16x16x32_bf16 v[232:235], a[156:159], a[12:15], v[232:235]
    buffer_load_dwordx4 v9, s[16:19], s33 offen lds
    v_lshlrev_b32 v81, 16, v47
    v_mfma_f32_16x16x32_bf16 v[236:239], a[160:163], a[12:15], v[236:239]
    v_and_b32 v82, s36, v43
    v_and_b32 v83, s36, v47
    v_mfma_f32_16x16x32_bf16 v[240:243], a[152:155], a[16:19], v[240:243]
    ds_read_b128 a[12:15], v15 offset:30208
    v_add_f32 v66, v48, v49
    v_mfma_f32_16x16x32_bf16 v[244:247], a[156:159], a[16:19], v[244:247]
    v_add_f32 v58, v50, v51
    v_sub_f32 v48, v49, v48
    v_sub_f32 v50, v51, v50
    v_mfma_f32_16x16x32_bf16 v[248:251], a[160:163], a[16:19], v[248:251]
    v_add_f32 v67, v80, v81
    s_barrier
    s_waitcnt vmcnt(22)
    v_mfma_f32_16x16x32_bf16 v[168:171], a[164:167], a[20:23], v[168:171]
    ds_read_b128 a[16:19], v10 offset:32768
    s_mov_b32 s31, 122880
    v_mfma_f32_16x16x32_bf16 v[172:175], a[168:171], a[20:23], v[172:175]
    buffer_load_dwordx4 a[224:227], v28, s[20:23], s31 offen offset:0 sc1
    v_mfma_f32_16x16x32_bf16 v[176:179], a[172:175], a[20:23], v[176:179]
    v_add_f32 v59, v82, v83
    s_waitcnt lgkmcnt(4)
    v_mfma_f32_16x16x32_bf16 v[180:183], a[164:167], a[24:27], v[180:183]
    ds_read_b128 a[20:23], v10 offset:35072
    v_sub_f32 v80, v81, v80
    v_mfma_f32_16x16x32_bf16 v[184:187], a[168:171], a[24:27], v[184:187]
    buffer_load_dwordx4 a[228:231], v28, s[20:23], s31 offen offset:1024 sc1
    v_sub_f32 v82, v83, v82
    v_mfma_f32_16x16x32_bf16 v[188:191], a[172:175], a[24:27], v[188:191]
    v_cvt_pk_bf16_f32 v66, v66, v58
    v_cvt_pk_bf16_f32 v58, v48, v50
    v_mfma_f32_16x16x32_bf16 v[192:195], a[164:167], a[28:31], v[192:195]
    ds_read_b128 a[24:27], v10 offset:37376
    v_cvt_pk_bf16_f32 v67, v67, v59
    v_mfma_f32_16x16x32_bf16 v[196:199], a[168:171], a[28:31], v[196:199]
    buffer_load_dwordx4 a[232:235], v28, s[20:23], s31 offen offset:2048 sc1
    v_mfma_f32_16x16x32_bf16 v[200:203], a[172:175], a[28:31], v[200:203]
    v_cvt_pk_bf16_f32 v59, v80, v82
    ds_read_b128 v[40:43], v23 offset:55296
    v_mfma_f32_16x16x32_bf16 v[204:207], a[164:167], a[0:3], v[204:207]
    ds_read_b128 a[28:31], v10 offset:39680
    ds_read_b128 v[44:47], v23 offset:39168
    v_mfma_f32_16x16x32_bf16 v[208:211], a[168:171], a[0:3], v[208:211]
    ds_write_b64 v16, v[52:53] offset:0
    v_mfma_f32_16x16x32_bf16 v[212:215], a[172:175], a[0:3], v[212:215]
    s_waitcnt lgkmcnt(7)
    v_mfma_f32_16x16x32_bf16 v[216:219], a[164:167], a[4:7], v[216:219]
    ds_read_b128 a[0:3], v10 offset:41984
    v_mfma_f32_16x16x32_bf16 v[220:223], a[168:171], a[4:7], v[220:223]
    ds_write_b64 v16, v[54:55] offset:8
    v_mfma_f32_16x16x32_bf16 v[224:227], a[172:175], a[4:7], v[224:227]
    ds_write_b64 v17, v[56:57] offset:0
    v_mfma_f32_16x16x32_bf16 v[228:231], a[164:167], a[8:11], v[228:231]
    ds_read_b128 a[4:7], v10 offset:44288
    v_mfma_f32_16x16x32_bf16 v[232:235], a[168:171], a[8:11], v[232:235]
    ds_write_b64 v17, v[58:59] offset:8
    v_mfma_f32_16x16x32_bf16 v[236:239], a[172:175], a[8:11], v[236:239]
    v_lshlrev_b32 v48, 16, v32
    v_lshlrev_b32 v49, 16, v36
    v_mfma_f32_16x16x32_bf16 v[240:243], a[164:167], a[12:15], v[240:243]
    ds_read_b128 a[8:11], v10 offset:46592
    v_and_b32 v50, s36, v32
    v_mfma_f32_16x16x32_bf16 v[244:247], a[168:171], a[12:15], v[244:247]
    v_and_b32 v51, s36, v36
    v_lshlrev_b32 v80, 16, v33
    v_mfma_f32_16x16x32_bf16 v[248:251], a[172:175], a[12:15], v[248:251]
    s_waitcnt vmcnt(22)
    s_waitcnt lgkmcnt(10)
    v_mfma_f32_16x16x32_bf16 v[84:87], a[176:179], a[16:19], v[84:87]
    ds_read_b128 a[12:15], v11 offset:32768
    s_mov_b32 s31, 135168
    v_mfma_f32_16x16x32_bf16 v[88:91], a[180:183], a[16:19], v[88:91]
    buffer_load_dwordx4 a[236:239], v28, s[20:23], s31 offen offset:0 sc1
    v_mfma_f32_16x16x32_bf16 v[92:95], a[184:187], a[16:19], v[92:95]
    v_lshlrev_b32 v81, 16, v37
    v_and_b32 v82, s36, v33
    v_mfma_f32_16x16x32_bf16 v[96:99], a[176:179], a[20:23], v[96:99]
    ds_read_b128 a[16:19], v11 offset:35072
    v_and_b32 v83, s36, v37
    v_mfma_f32_16x16x32_bf16 v[100:103], a[180:183], a[20:23], v[100:103]
    buffer_load_dwordx4 a[240:243], v28, s[20:23], s31 offen offset:1024 sc1
    v_mfma_f32_16x16x32_bf16 v[104:107], a[184:187], a[20:23], v[104:107]
    v_add_f32 v68, v48, v49
    v_add_f32 v52, v50, v51
    v_mfma_f32_16x16x32_bf16 v[108:111], a[176:179], a[24:27], v[108:111]
    ds_read_b128 a[20:23], v11 offset:37376
    v_sub_f32 v48, v49, v48
    v_mfma_f32_16x16x32_bf16 v[112:115], a[180:183], a[24:27], v[112:115]
    buffer_load_dwordx4 a[244:247], v28, s[20:23], s31 offen offset:2048 sc1
    v_mfma_f32_16x16x32_bf16 v[116:119], a[184:187], a[24:27], v[116:119]
    v_sub_f32 v50, v51, v50
    s_waitcnt lgkmcnt(5)
    v_mfma_f32_16x16x32_bf16 v[120:123], a[176:179], a[28:31], v[120:123]
    ds_read_b128 a[24:27], v11 offset:39680
    v_add_f32 v69, v80, v81
    v_mfma_f32_16x16x32_bf16 v[124:127], a[180:183], a[28:31], v[124:127]
    v_add_f32 v53, v82, v83
    v_sub_f32 v80, v81, v80
    v_mfma_f32_16x16x32_bf16 v[128:131], a[184:187], a[28:31], v[128:131]
    v_sub_f32 v82, v83, v82
    v_cvt_pk_bf16_f32 v68, v68, v52
    v_mfma_f32_16x16x32_bf16 v[132:135], a[176:179], a[0:3], v[132:135]
    ds_read_b128 a[28:31], v11 offset:41984
    v_cvt_pk_bf16_f32 v52, v48, v50
    v_mfma_f32_16x16x32_bf16 v[136:139], a[180:183], a[0:3], v[136:139]
    v_lshlrev_b32 v48, 16, v34
    v_lshlrev_b32 v49, 16, v38
    v_mfma_f32_16x16x32_bf16 v[140:143], a[184:187], a[0:3], v[140:143]
    v_and_b32 v50, s36, v34
    v_and_b32 v51, s36, v38
    v_mfma_f32_16x16x32_bf16 v[144:147], a[176:179], a[4:7], v[144:147]
    ds_read_b128 a[0:3], v11 offset:44288
    v_cvt_pk_bf16_f32 v69, v69, v53
    v_mfma_f32_16x16x32_bf16 v[148:151], a[180:183], a[4:7], v[148:151]
    v_cvt_pk_bf16_f32 v53, v80, v82
    v_lshlrev_b32 v80, 16, v35
    v_mfma_f32_16x16x32_bf16 v[152:155], a[184:187], a[4:7], v[152:155]
    v_lshlrev_b32 v81, 16, v39
    s_waitcnt vmcnt(21)
    v_cmp_ne_u32 s[100:101], 0, v0
    s_cmp_eq_u64 s[100:101], -1
    s_cbranch_scc0 L_slowflagb
L_flagokb:
    s_waitcnt lgkmcnt(4)
    v_mfma_f32_16x16x32_bf16 v[156:159], a[176:179], a[8:11], v[156:159]
    ds_read_b128 a[4:7], v11 offset:46592
    v_and_b32 v82, s36, v35
    v_mfma_f32_16x16x32_bf16 v[160:163], a[180:183], a[8:11], v[160:163]
    v_and_b32 v83, s36, v39
    v_add_f32 v70, v48, v49
    v_mfma_f32_16x16x32_bf16 v[164:167], a[184:187], a[8:11], v[164:167]
    v_add_f32 v54, v50, v51
    v_sub_f32 v48, v49, v48
    v_mfma_f32_16x16x32_bf16 v[84:87], a[188:191], a[12:15], v[84:87]
    ds_read_b128 a[8:11], v12 offset:32768
    s_mov_b32 s31, 147456
    v_mfma_f32_16x16x32_bf16 v[88:91], a[192:195], a[12:15], v[88:91]
    buffer_load_dwordx4 a[32:35], v28, s[20:23], s31 offen offset:0 sc1
    v_mfma_f32_16x16x32_bf16 v[92:95], a[196:199], a[12:15], v[92:95]
    v_sub_f32 v50, v51, v50
    v_add_f32 v71, v80, v81
    v_mfma_f32_16x16x32_bf16 v[96:99], a[188:191], a[16:19], v[96:99]
    ds_read_b128 a[12:15], v12 offset:35072
    v_add_f32 v55, v82, v83
    v_mfma_f32_16x16x32_bf16 v[100:103], a[192:195], a[16:19], v[100:103]
    buffer_load_dwordx4 a[36:39], v28, s[20:23], s31 offen offset:1024 sc1
    v_mfma_f32_16x16x32_bf16 v[104:107], a[196:199], a[16:19], v[104:107]
    v_sub_f32 v80, v81, v80
    s_waitcnt lgkmcnt(4)
    v_mfma_f32_16x16x32_bf16 v[108:111], a[188:191], a[20:23], v[108:111]
    ds_read_b128 a[16:19], v12 offset:37376
    v_sub_f32 v82, v83, v82
    v_mfma_f32_16x16x32_bf16 v[112:115], a[192:195], a[20:23], v[112:115]
    buffer_load_dwordx4 a[40:43], v28, s[20:23], s31 offen offset:2048 sc1
    v_mfma_f32_16x16x32_bf16 v[116:119], a[196:199], a[20:23], v[116:119]
    v_cvt_pk_bf16_f32 v70, v70, v54
    v_cvt_pk_bf16_f32 v54, v48, v50
    v_mfma_f32_16x16x32_bf16 v[120:123], a[188:191], a[24:27], v[120:123]
    ds_read_b128 a[20:23], v12 offset:39680
    v_cvt_pk_bf16_f32 v71, v71, v55
    v_mfma_f32_16x16x32_bf16 v[124:127], a[192:195], a[24:27], v[124:127]
    v_cvt_pk_bf16_f32 v55, v80, v82
    v_mfma_f32_16x16x32_bf16 v[128:131], a[196:199], a[24:27], v[128:131]
    ds_write_b64 v18, v[52:53] offset:0
    v_mfma_f32_16x16x32_bf16 v[132:135], a[188:191], a[28:31], v[132:135]
    ds_read_b128 a[24:27], v12 offset:41984
    v_mfma_f32_16x16x32_bf16 v[136:139], a[192:195], a[28:31], v[136:139]
    ds_write_b64 v18, v[54:55] offset:8
    v_mfma_f32_16x16x32_bf16 v[140:143], a[196:199], a[28:31], v[140:143]
    v_lshlrev_b32 v48, 16, v40
    s_waitcnt lgkmcnt(6)
    v_mfma_f32_16x16x32_bf16 v[144:147], a[188:191], a[0:3], v[144:147]
    ds_read_b128 a[28:31], v12 offset:44288
    v_lshlrev_b32 v49, 16, v44
    v_mfma_f32_16x16x32_bf16 v[148:151], a[192:195], a[0:3], v[148:151]
    v_and_b32 v50, s36, v40
    v_and_b32 v51, s36, v44
    v_mfma_f32_16x16x32_bf16 v[152:155], a[196:199], a[0:3], v[152:155]
    v_lshlrev_b32 v80, 16, v41
    v_lshlrev_b32 v81, 16, v45
    v_mfma_f32_16x16x32_bf16 v[156:159], a[188:191], a[4:7], v[156:159]
    ds_read_b128 a[0:3], v12 offset:46592
    v_and_b32 v82, s36, v41
    v_mfma_f32_16x16x32_bf16 v[160:163], a[192:195], a[4:7], v[160:163]
    v_and_b32 v83, s36, v45
    v_add_f32 v72, v48, v49
    v_mfma_f32_16x16x32_bf16 v[164:167], a[196:199], a[4:7], v[164:167]
    v_add_f32 v56, v50, v51
    s_waitcnt vmcnt(19)
    v_mfma_f32_16x16x32_bf16 v[84:87], a[200:203], a[8:11], v[84:87]
    ds_read_b128 a[4:7], v13 offset:32768
    s_mov_b32 s31, 159744
    v_mfma_f32_16x16x32_bf16 v[88:91], a[204:207], a[8:11], v[88:91]
    buffer_load_dwordx4 a[44:47], v28, s[20:23], s31 offen offset:0 sc1
    v_mfma_f32_16x16x32_bf16 v[92:95], a[208:211], a[8:11], v[92:95]
    v_sub_f32 v48, v49, v48
    s_waitcnt lgkmcnt(6)
    v_mfma_f32_16x16x32_bf16 v[96:99], a[200:203], a[12:15], v[96:99]
    ds_read_b128 a[8:11], v13 offset:35072
    v_sub_f32 v50, v51, v50
    v_mfma_f32_16x16x32_bf16 v[100:103], a[204:207], a[12:15], v[100:103]
    buffer_load_dwordx4 a[48:51], v28, s[20:23], s31 offen offset:1024 sc1
    v_mfma_f32_16x16x32_bf16 v[104:107], a[208:211], a[12:15], v[104:107]
    v_add_f32 v73, v80, v81
    v_add_f32 v57, v82, v83
    v_mfma_f32_16x16x32_bf16 v[108:111], a[200:203], a[16:19], v[108:111]
    ds_read_b128 a[12:15], v13 offset:37376
    v_sub_f32 v80, v81, v80
    v_mfma_f32_16x16x32_bf16 v[112:115], a[204:207], a[16:19], v[112:115]
    buffer_load_dwordx4 a[52:55], v28, s[20:23], s31 offen offset:2048 sc1
    v_mfma_f32_16x16x32_bf16 v[116:119], a[208:211], a[16:19], v[116:119]
    v_sub_f32 v82, v83, v82
    v_cvt_pk_bf16_f32 v72, v72, v56
    v_mfma_f32_16x16x32_bf16 v[120:123], a[200:203], a[20:23], v[120:123]
    ds_read_b128 a[16:19], v13 offset:39680
    v_cvt_pk_bf16_f32 v56, v48, v50
    v_mfma_f32_16x16x32_bf16 v[124:127], a[204:207], a[20:23], v[124:127]
    v_lshlrev_b32 v48, 16, v42
    v_lshlrev_b32 v49, 16, v46
    v_mfma_f32_16x16x32_bf16 v[128:131], a[208:211], a[20:23], v[128:131]
    v_and_b32 v50, s36, v42
    s_waitcnt lgkmcnt(4)
    v_mfma_f32_16x16x32_bf16 v[132:135], a[200:203], a[24:27], v[132:135]
    ds_read_b128 a[20:23], v13 offset:41984
    v_and_b32 v51, s36, v46
    v_mfma_f32_16x16x32_bf16 v[136:139], a[204:207], a[24:27], v[136:139]
    v_cvt_pk_bf16_f32 v73, v73, v57
    v_cvt_pk_bf16_f32 v57, v80, v82
    v_mfma_f32_16x16x32_bf16 v[140:143], a[208:211], a[24:27], v[140:143]
    v_lshlrev_b32 v80, 16, v43
    v_lshlrev_b32 v81, 16, v47
    v_mfma_f32_16x16x32_bf16 v[144:147], a[200:203], a[28:31], v[144:147]
    ds_read_b128 a[24:27], v13 offset:44288
    v_and_b32 v82, s36, v43
    v_mfma_f32_16x16x32_bf16 v[148:151], a[204:207], a[28:31], v[148:151]
    v_and_b32 v83, s36, v47
    v_add_f32 v74, v48, v49
    v_mfma_f32_16x16x32_bf16 v[152:155], a[208:211], a[28:31], v[152:155]
    v_add_f32 v58, v50, v51
    v_sub_f32 v48, v49, v48
    v_mfma_f32_16x16x32_bf16 v[156:159], a[200:203], a[0:3], v[156:159]
    ds_read_b128 a[28:31], v13 offset:46592
    v_sub_f32 v50, v51, v50
    v_mfma_f32_16x16x32_bf16 v[160:163], a[204:207], a[0:3], v[160:163]
    v_add_f32 v75, v80, v81
    v_add_f32 v59, v82, v83
    v_mfma_f32_16x16x32_bf16 v[164:167], a[208:211], a[0:3], v[164:167]
    s_waitcnt vmcnt(15)
    s_waitcnt lgkmcnt(4)
    v_mfma_f32_16x16x32_bf16 v[84:87], a[212:215], a[4:7], v[84:87]
    ds_read_b128 a[0:3], v14 offset:32768
    s_mov_b32 s31, 172032
    v_mfma_f32_16x16x32_bf16 v[88:91], a[216:219], a[4:7], v[88:91]
    buffer_load_dwordx4 a[56:59], v28, s[20:23], s31 offen offset:0 sc1
    v_mfma_f32_16x16x32_bf16 v[92:95], a[220:223], a[4:7], v[92:95]
    v_sub_f32 v80, v81, v80
    v_sub_f32 v82, v83, v82
    v_mfma_f32_16x16x32_bf16 v[96:99], a[212:215], a[8:11], v[96:99]
    ds_read_b128 a[4:7], v14 offset:35072
    v_cvt_pk_bf16_f32 v74, v74, v58
    v_mfma_f32_16x16x32_bf16 v[100:103], a[216:219], a[8:11], v[100:103]
    buffer_load_dwordx4 a[60:63], v28, s[20:23], s31 offen offset:1024 sc1
    v_mfma_f32_16x16x32_bf16 v[104:107], a[220:223], a[8:11], v[104:107]
    v_cvt_pk_bf16_f32 v58, v48, v50
    v_cvt_pk_bf16_f32 v75, v75, v59
    v_mfma_f32_16x16x32_bf16 v[108:111], a[212:215], a[12:15], v[108:111]
    ds_read_b128 a[8:11], v14 offset:37376
    v_cvt_pk_bf16_f32 v59, v80, v82
    v_mfma_f32_16x16x32_bf16 v[112:115], a[216:219], a[12:15], v[112:115]
    buffer_load_dwordx4 a[64:67], v28, s[20:23], s31 offen offset:2048 sc1
    v_mfma_f32_16x16x32_bf16 v[116:119], a[220:223], a[12:15], v[116:119]
    s_waitcnt lgkmcnt(4)
    v_mfma_f32_16x16x32_bf16 v[120:123], a[212:215], a[16:19], v[120:123]
    ds_read_b128 a[12:15], v14 offset:39680
    v_mfma_f32_16x16x32_bf16 v[124:127], a[216:219], a[16:19], v[124:127]
    ds_write_b64 v19, v[56:57] offset:0
    v_mfma_f32_16x16x32_bf16 v[128:131], a[220:223], a[16:19], v[128:131]
    ds_write_b64 v19, v[58:59] offset:8
    v_mfma_f32_16x16x32_bf16 v[132:135], a[212:215], a[20:23], v[132:135]
    ds_read_b128 a[16:19], v14 offset:41984
    v_mfma_f32_16x16x32_bf16 v[136:139], a[216:219], a[20:23], v[136:139]
    v_mfma_f32_16x16x32_bf16 v[140:143], a[220:223], a[20:23], v[140:143]
    v_mfma_f32_16x16x32_bf16 v[144:147], a[212:215], a[24:27], v[144:147]
    ds_read_b128 a[20:23], v14 offset:44288
    v_mfma_f32_16x16x32_bf16 v[148:151], a[216:219], a[24:27], v[148:151]
    v_mfma_f32_16x16x32_bf16 v[152:155], a[220:223], a[24:27], v[152:155]
    s_waitcnt lgkmcnt(6)
    v_mfma_f32_16x16x32_bf16 v[156:159], a[212:215], a[28:31], v[156:159]
    ds_read_b128 a[24:27], v14 offset:46592
    v_mfma_f32_16x16x32_bf16 v[160:163], a[216:219], a[28:31], v[160:163]
    v_mfma_f32_16x16x32_bf16 v[164:167], a[220:223], a[28:31], v[164:167]
    s_waitcnt vmcnt(12)
    v_mfma_f32_16x16x32_bf16 v[84:87], a[224:227], a[0:3], v[84:87]
    ds_read_b128 a[28:31], v15 offset:32768
    s_mov_b32 s31, 184320
    v_mfma_f32_16x16x32_bf16 v[88:91], a[228:231], a[0:3], v[88:91]
    buffer_load_dwordx4 a[68:71], v28, s[20:23], s31 offen offset:0 sc1
    v_mfma_f32_16x16x32_bf16 v[92:95], a[232:235], a[0:3], v[92:95]
    v_mfma_f32_16x16x32_bf16 v[96:99], a[224:227], a[4:7], v[96:99]
    ds_read_b128 a[0:3], v15 offset:35072
    v_mfma_f32_16x16x32_bf16 v[100:103], a[228:231], a[4:7], v[100:103]
    buffer_load_dwordx4 a[72:75], v28, s[20:23], s31 offen offset:1024 sc1
    v_mfma_f32_16x16x32_bf16 v[104:107], a[232:235], a[4:7], v[104:107]
    s_waitcnt lgkmcnt(4)
    v_mfma_f32_16x16x32_bf16 v[108:111], a[224:227], a[8:11], v[108:111]
    ds_read_b128 a[4:7], v15 offset:37376
    v_mfma_f32_16x16x32_bf16 v[112:115], a[228:231], a[8:11], v[112:115]
    buffer_load_dwordx4 a[76:79], v28, s[20:23], s31 offen offset:2048 sc1
    v_mfma_f32_16x16x32_bf16 v[116:119], a[232:235], a[8:11], v[116:119]
    v_mfma_f32_16x16x32_bf16 v[120:123], a[224:227], a[12:15], v[120:123]
    ds_read_b128 a[8:11], v15 offset:39680
    v_mfma_f32_16x16x32_bf16 v[124:127], a[228:231], a[12:15], v[124:127]
    v_mfma_f32_16x16x32_bf16 v[128:131], a[232:235], a[12:15], v[128:131]
    s_barrier
    v_mfma_f32_16x16x32_bf16 v[132:135], a[224:227], a[16:19], v[132:135]
    ds_read_b128 a[12:15], v15 offset:41984
    v_mfma_f32_16x16x32_bf16 v[136:139], a[228:231], a[16:19], v[136:139]
    ds_write_b64 v16, v[60:61] offset:16384
    v_mfma_f32_16x16x32_bf16 v[140:143], a[232:235], a[16:19], v[140:143]
    s_waitcnt lgkmcnt(5)
    v_mfma_f32_16x16x32_bf16 v[144:147], a[224:227], a[20:23], v[144:147]
    ds_read_b128 a[16:19], v15 offset:44288
    v_mfma_f32_16x16x32_bf16 v[148:151], a[228:231], a[20:23], v[148:151]
    ds_write_b64 v16, v[62:63] offset:16392
    v_mfma_f32_16x16x32_bf16 v[152:155], a[232:235], a[20:23], v[152:155]
    ds_write_b64 v17, v[64:65] offset:16384
    v_mfma_f32_16x16x32_bf16 v[156:159], a[224:227], a[24:27], v[156:159]
    ds_read_b128 a[20:23], v15 offset:46592
    v_mfma_f32_16x16x32_bf16 v[160:163], a[228:231], a[24:27], v[160:163]
    ds_write_b64 v17, v[66:67] offset:16392
    v_mfma_f32_16x16x32_bf16 v[164:167], a[232:235], a[24:27], v[164:167]
    s_waitcnt vmcnt(12)
    v_mfma_f32_16x16x32_bf16 v[84:87], a[236:239], a[28:31], v[84:87]
    ds_read_b128 a[24:27], v10 offset:0
    s_mov_b32 s31, 196608
    v_mfma_f32_16x16x32_bf16 v[88:91], a[240:243], a[28:31], v[88:91]
    buffer_load_dwordx4 a[80:83], v28, s[20:23], s31 offen offset:0 sc1
    v_mfma_f32_16x16x32_bf16 v[92:95], a[244:247], a[28:31], v[92:95]
    s_waitcnt lgkmcnt(8)
    v_mfma_f32_16x16x32_bf16 v[96:99], a[236:239], a[0:3], v[96:99]
    ds_read_b128 a[28:31], v10 offset:2304
    v_mfma_f32_16x16x32_bf16 v[100:103], a[240:243], a[0:3], v[100:103]
    buffer_load_dwordx4 a[84:87], v28, s[20:23], s31 offen offset:1024 sc1
    v_mfma_f32_16x16x32_bf16 v[104:107], a[244:247], a[0:3], v[104:107]
    ds_write_b64 v18, v[68:69] offset:16384
    v_mfma_f32_16x16x32_bf16 v[108:111], a[236:239], a[4:7], v[108:111]
    ds_read_b128 a[0:3], v10 offset:4608
    v_mfma_f32_16x16x32_bf16 v[112:115], a[240:243], a[4:7], v[112:115]
    buffer_load_dwordx4 a[88:91], v28, s[20:23], s31 offen offset:2048 sc1
    v_mfma_f32_16x16x32_bf16 v[116:119], a[244:247], a[4:7], v[116:119]
    ds_write_b64 v18, v[70:71] offset:16392
    v_mfma_f32_16x16x32_bf16 v[120:123], a[236:239], a[8:11], v[120:123]
    ds_read_b128 a[4:7], v10 offset:6912
    v_mfma_f32_16x16x32_bf16 v[124:127], a[240:243], a[8:11], v[124:127]
    ds_write_b64 v19, v[72:73] offset:16384
    v_mfma_f32_16x16x32_bf16 v[128:131], a[244:247], a[8:11], v[128:131]
    s_waitcnt lgkmcnt(8)
    v_mfma_f32_16x16x32_bf16 v[132:135], a[236:239], a[12:15], v[132:135]
    ds_read_b128 a[8:11], v10 offset:9216
    v_mfma_f32_16x16x32_bf16 v[136:139], a[240:243], a[12:15], v[136:139]
    ds_write_b64 v19, v[74:75] offset:16392
    v_mfma_f32_16x16x32_bf16 v[140:143], a[244:247], a[12:15], v[140:143]
    ds_read_b128 v[32:35], v24 offset:55296
    ds_read_b128 v[36:39], v24 offset:39168
    v_mfma_f32_16x16x32_bf16 v[144:147], a[236:239], a[16:19], v[144:147]
    ds_read_b128 a[12:15], v10 offset:11520
    ds_read_b128 v[40:43], v25 offset:55296
    v_mfma_f32_16x16x32_bf16 v[148:151], a[240:243], a[16:19], v[148:151]
    ds_read_b128 v[44:47], v25 offset:39168
    v_mfma_f32_16x16x32_bf16 v[152:155], a[244:247], a[16:19], v[152:155]
    v_mfma_f32_16x16x32_bf16 v[156:159], a[236:239], a[20:23], v[156:159]
    s_waitcnt lgkmcnt(13)
    ds_read_b128 a[16:19], v10 offset:13824
    v_mfma_f32_16x16x32_bf16 v[160:163], a[240:243], a[20:23], v[160:163]
    v_mfma_f32_16x16x32_bf16 v[164:167], a[244:247], a[20:23], v[164:167]
    s_waitcnt vmcnt(12)
    v_mfma_f32_16x16x32_bf16 v[168:171], a[32:35], a[24:27], v[168:171]
    ds_read_b128 a[20:23], v11 offset:0
    s_mov_b32 s31, 208896
    v_mfma_f32_16x16x32_bf16 v[172:175], a[36:39], a[24:27], v[172:175]
    buffer_load_dwordx4 a[92:95], v28, s[20:23], s31 offen offset:0 sc1
    v_mfma_f32_16x16x32_bf16 v[176:179], a[40:43], a[24:27], v[176:179]
    s_waitcnt lgkmcnt(10)
    v_mfma_f32_16x16x32_bf16 v[180:183], a[32:35], a[28:31], v[180:183]
    ds_read_b128 a[24:27], v11 offset:2304
    v_mfma_f32_16x16x32_bf16 v[184:187], a[36:39], a[28:31], v[184:187]
    buffer_load_dwordx4 a[96:99], v28, s[20:23], s31 offen offset:1024 sc1
    v_mfma_f32_16x16x32_bf16 v[188:191], a[40:43], a[28:31], v[188:191]
    s_waitcnt lgkmcnt(6)
    v_lshlrev_b32 v48, 16, v32
    v_mfma_f32_16x16x32_bf16 v[192:195], a[32:35], a[0:3], v[192:195]
    ds_read_b128 a[28:31], v11 offset:4608
    v_lshlrev_b32 v49, 16, v36
    v_mfma_f32_16x16x32_bf16 v[196:199], a[36:39], a[0:3], v[196:199]
    buffer_load_dwordx4 a[100:103], v28, s[20:23], s31 offen offset:2048 sc1
    v_mfma_f32_16x16x32_bf16 v[200:203], a[40:43], a[0:3], v[200:203]
    s_mov_b32 s31, 663552
    v_and_b32 v50, s36, v32
    v_mfma_f32_16x16x32_bf16 v[204:207], a[32:35], a[4:7], v[204:207]
    ds_read_b128 a[0:3], v11 offset:6912
    v_and_b32 v51, s36, v36
    v_mfma_f32_16x16x32_bf16 v[208:211], a[36:39], a[4:7], v[208:211]
    buffer_load_dwordx4 a[104:107], v28, s[20:23], s31 offen offset:0 sc1
    v_mfma_f32_16x16x32_bf16 v[212:215], a[40:43], a[4:7], v[212:215]
    v_lshlrev_b32 v80, 16, v33
    v_lshlrev_b32 v81, 16, v37
    v_mfma_f32_16x16x32_bf16 v[216:219], a[32:35], a[8:11], v[216:219]
    ds_read_b128 a[4:7], v11 offset:9216
    v_and_b32 v82, s36, v33
    v_mfma_f32_16x16x32_bf16 v[220:223], a[36:39], a[8:11], v[220:223]
    buffer_load_dwordx4 a[108:111], v28, s[20:23], s31 offen offset:1024 sc1
    v_mfma_f32_16x16x32_bf16 v[224:227], a[40:43], a[8:11], v[224:227]
    v_and_b32 v83, s36, v37
    s_waitcnt lgkmcnt(4)
    v_mfma_f32_16x16x32_bf16 v[228:231], a[32:35], a[12:15], v[228:231]
    ds_read_b128 a[8:11], v11 offset:11520
    v_add_f32 v60, v48, v49
    v_mfma_f32_16x16x32_bf16 v[232:235], a[36:39], a[12:15], v[232:235]
    buffer_load_dwordx4 a[112:115], v28, s[20:23], s31 offen offset:2048 sc1
    v_mfma_f32_16x16x32_bf16 v[236:239], a[40:43], a[12:15], v[236:239]
    v_add_f32 v52, v50, v51
    v_sub_f32 v48, v49, v48
    v_mfma_f32_16x16x32_bf16 v[240:243], a[32:35], a[16:19], v[240:243]
    ds_read_b128 a[12:15], v11 offset:13824
    v_sub_f32 v50, v51, v50
    v_mfma_f32_16x16x32_bf16 v[244:247], a[36:39], a[16:19], v[244:247]
    v_add_f32 v61, v80, v81
    v_add_f32 v53, v82, v83
    v_mfma_f32_16x16x32_bf16 v[248:251], a[40:43], a[16:19], v[248:251]
    v_sub_f32 v80, v81, v80
    s_waitcnt vmcnt(15)
    v_mfma_f32_16x16x32_bf16 v[168:171], a[44:47], a[20:23], v[168:171]
    ds_read_b128 a[16:19], v12 offset:0
    s_mov_b32 s31, 221184
    v_mfma_f32_16x16x32_bf16 v[172:175], a[48:51], a[20:23], v[172:175]
    buffer_load_dwordx4 a[116:119], v28, s[20:23], s31 offen offset:0 sc1
    v_mfma_f32_16x16x32_bf16 v[176:179], a[52:55], a[20:23], v[176:179]
    v_sub_f32 v82, v83, v82
    s_waitcnt lgkmcnt(4)
    v_mfma_f32_16x16x32_bf16 v[180:183], a[44:47], a[24:27], v[180:183]
    ds_read_b128 a[20:23], v12 offset:2304
    v_cvt_pk_bf16_f32 v60, v60, v52
    v_mfma_f32_16x16x32_bf16 v[184:187], a[48:51], a[24:27], v[184:187]
    buffer_load_dwordx4 a[120:123], v28, s[20:23], s31 offen offset:1024 sc1
    v_cvt_pk_bf16_f32 v52, v48, v50
    v_mfma_f32_16x16x32_bf16 v[188:191], a[52:55], a[24:27], v[188:191]
    v_lshlrev_b32 v48, 16, v34
    v_lshlrev_b32 v49, 16, v38
    v_mfma_f32_16x16x32_bf16 v[192:195], a[44:47], a[28:31], v[192:195]
    ds_read_b128 a[24:27], v12 offset:4608
    v_and_b32 v50, s36, v34
    v_mfma_f32_16x16x32_bf16 v[196:199], a[48:51], a[28:31], v[196:199]
    buffer_load_dwordx4 a[124:127], v28, s[20:23], s31 offen offset:2048 sc1
    v_mfma_f32_16x16x32_bf16 v[200:203], a[52:55], a[28:31], v[200:203]
    v_and_b32 v51, s36, v38
    v_cvt_pk_bf16_f32 v61, v61, v53
    v_mfma_f32_16x16x32_bf16 v[204:207], a[44:47], a[0:3], v[204:207]
    ds_read_b128 a[28:31], v12 offset:6912
    v_cvt_pk_bf16_f32 v53, v80, v82
    v_mfma_f32_16x16x32_bf16 v[208:211], a[48:51], a[0:3], v[208:211]
    v_lshlrev_b32 v80, 16, v35
    v_lshlrev_b32 v81, 16, v39
    v_mfma_f32_16x16x32_bf16 v[212:215], a[52:55], a[0:3], v[212:215]
    v_and_b32 v82, s36, v35
    s_waitcnt lgkmcnt(4)
    v_mfma_f32_16x16x32_bf16 v[216:219], a[44:47], a[4:7], v[216:219]
    ds_read_b128 a[0:3], v12 offset:9216
    v_and_b32 v83, s36, v39
    v_mfma_f32_16x16x32_bf16 v[220:223], a[48:51], a[4:7], v[220:223]
    v_add_f32 v62, v48, v49
    v_add_f32 v54, v50, v51
    v_mfma_f32_16x16x32_bf16 v[224:227], a[52:55], a[4:7], v[224:227]
    v_sub_f32 v48, v49, v48
    v_sub_f32 v50, v51, v50
    v_mfma_f32_16x16x32_bf16 v[228:231], a[44:47], a[8:11], v[228:231]
    ds_read_b128 a[4:7], v12 offset:11520
    v_add_f32 v63, v80, v81
    v_mfma_f32_16x16x32_bf16 v[232:235], a[48:51], a[8:11], v[232:235]
    v_add_f32 v55, v82, v83
    v_sub_f32 v80, v81, v80
    v_mfma_f32_16x16x32_bf16 v[236:239], a[52:55], a[8:11], v[236:239]
    v_sub_f32 v82, v83, v82
    v_cvt_pk_bf16_f32 v62, v62, v54
    v_mfma_f32_16x16x32_bf16 v[240:243], a[44:47], a[12:15], v[240:243]
    ds_read_b128 a[8:11], v12 offset:13824
    v_cvt_pk_bf16_f32 v54, v48, v50
    v_mfma_f32_16x16x32_bf16 v[244:247], a[48:51], a[12:15], v[244:247]
    v_cvt_pk_bf16_f32 v63, v63, v55
    v_cvt_pk_bf16_f32 v55, v80, v82
    v_mfma_f32_16x16x32_bf16 v[248:251], a[52:55], a[12:15], v[248:251]
    s_waitcnt vmcnt(15)
    s_waitcnt lgkmcnt(4)
    v_mfma_f32_16x16x32_bf16 v[168:171], a[56:59], a[16:19], v[168:171]
    ds_read_b128 a[12:15], v13 offset:0
    s_mov_b32 s31, 233472
    v_mfma_f32_16x16x32_bf16 v[172:175], a[60:63], a[16:19], v[172:175]
    buffer_load_dwordx4 a[128:131], v28, s[20:23], s31 offen offset:0 sc1
    v_mfma_f32_16x16x32_bf16 v[176:179], a[64:67], a[16:19], v[176:179]
    ds_read_b128 v[32:35], v26 offset:55296
    ds_read_b128 v[36:39], v26 offset:39168
    v_mfma_f32_16x16x32_bf16 v[180:183], a[56:59], a[20:23], v[180:183]
    ds_read_b128 a[16:19], v13 offset:2304
    v_lshlrev_b32 v48, 16, v40
    v_mfma_f32_16x16x32_bf16 v[184:187], a[60:63], a[20:23], v[184:187]
    buffer_load_dwordx4 a[132:135], v28, s[20:23], s31 offen offset:1024 sc1
    v_mfma_f32_16x16x32_bf16 v[188:191], a[64:67], a[20:23], v[188:191]
    v_lshlrev_b32 v49, 16, v44
    v_and_b32 v50, s36, v40
    v_mfma_f32_16x16x32_bf16 v[192:195], a[56:59], a[24:27], v[192:195]
    ds_read_b128 a[20:23], v13 offset:4608
    v_and_b32 v51, s36, v44
    v_mfma_f32_16x16x32_bf16 v[196:199], a[60:63], a[24:27], v[196:199]
    buffer_load_dwordx4 a[136:139], v28, s[20:23], s31 offen offset:2048 sc1
    v_mfma_f32_16x16x32_bf16 v[200:203], a[64:67], a[24:27], v[200:203]
    s_mov_b32 s31, 675840
    s_waitcnt lgkmcnt(6)
    v_mfma_f32_16x16x32_bf16 v[204:207], a[56:59], a[28:31], v[204:207]
    ds_read_b128 a[24:27], v13 offset:6912
    v_lshlrev_b32 v80, 16, v41
    v_mfma_f32_16x16x32_bf16 v[208:211], a[60:63], a[28:31], v[208:211]
    buffer_load_dwordx4 a[140:143], v28, s[20:23], s31 offen offset:0 sc1
    v_mfma_f32_16x16x32_bf16 v[212:215], a[64:67], a[28:31], v[212:215]
    v_lshlrev_b32 v81, 16, v45
    v_and_b32 v82, s36, v41
    v_mfma_f32_16x16x32_bf16 v[216:219], a[56:59], a[0:3], v[216:219]
    ds_read_b128 a[28:31], v13 offset:9216
    v_and_b32 v83, s36, v45
    v_mfma_f32_16x16x32_bf16 v[220:223], a[60:63], a[0:3], v[220:223]
    buffer_load_dwordx4 a[144:147], v28, s[20:23], s31 offen offset:1024 sc1
    v_mfma_f32_16x16x32_bf16 v[224:227], a[64:67], a[0:3], v[224:227]
    v_add_f32 v64, v48, v49
    v_add_f32 v56, v50, v51
    v_mfma_f32_16x16x32_bf16 v[228:231], a[56:59], a[4:7], v[228:231]
    ds_read_b128 a[0:3], v13 offset:11520
    v_sub_f32 v48, v49, v48
    v_mfma_f32_16x16x32_bf16 v[232:235], a[60:63], a[4:7], v[232:235]
    buffer_load_dwordx4 a[148:151], v28, s[20:23], s31 offen offset:2048 sc1
    v_mfma_f32_16x16x32_bf16 v[236:239], a[64:67], a[4:7], v[236:239]
    v_sub_f32 v50, v51, v50
    s_waitcnt lgkmcnt(4)
    v_mfma_f32_16x16x32_bf16 v[240:243], a[56:59], a[8:11], v[240:243]
    ds_read_b128 a[4:7], v13 offset:13824
    v_add_f32 v65, v80, v81
    v_mfma_f32_16x16x32_bf16 v[244:247], a[60:63], a[8:11], v[244:247]
    v_add_f32 v57, v82, v83
    v_sub_f32 v80, v81, v80
    v_mfma_f32_16x16x32_bf16 v[248:251], a[64:67], a[8:11], v[248:251]
    v_sub_f32 v82, v83, v82
    s_waitcnt vmcnt(18)
    v_mfma_f32_16x16x32_bf16 v[168:171], a[68:71], a[12:15], v[168:171]
    ds_read_b128 a[8:11], v14 offset:0
    s_mov_b32 s31, 245760
L_pad2:
    s_cbranch_vccnz L_pad3
    v_mfma_f32_16x16x32_bf16 v[172:175], a[72:75], a[12:15], v[172:175]
    buffer_load_dwordx4 a[152:155], v28, s[20:23], s31 offen offset:0 sc1
    v_mfma_f32_16x16x32_bf16 v[176:179], a[76:79], a[12:15], v[176:179]
    v_cvt_pk_bf16_f32 v64, v64, v56
    v_cvt_pk_bf16_f32 v56, v48, v50
    v_mfma_f32_16x16x32_bf16 v[180:183], a[68:71], a[16:19], v[180:183]
    ds_read_b128 a[12:15], v14 offset:2304
    v_lshlrev_b32 v48, 16, v42
    v_mfma_f32_16x16x32_bf16 v[184:187], a[72:75], a[16:19], v[184:187]
    buffer_load_dwordx4 a[156:159], v28, s[20:23], s31 offen offset:1024 sc1
    v_mfma_f32_16x16x32_bf16 v[188:191], a[76:79], a[16:19], v[188:191]
    v_lshlrev_b32 v49, 16, v46
    s_waitcnt lgkmcnt(4)
    v_mfma_f32_16x16x32_bf16 v[192:195], a[68:71], a[20:23], v[192:195]
    ds_read_b128 a[16:19], v14 offset:4608
    v_and_b32 v50, s36, v42
    v_mfma_f32_16x16x32_bf16 v[196:199], a[72:75], a[20:23], v[196:199]
    buffer_load_dwordx4 a[160:163], v28, s[20:23], s31 offen offset:2048 sc1
    v_mfma_f32_16x16x32_bf16 v[200:203], a[76:79], a[20:23], v[200:203]
    v_and_b32 v51, s36, v46
    v_cvt_pk_bf16_f32 v65, v65, v57
    v_mfma_f32_16x16x32_bf16 v[204:207], a[68:71], a[24:27], v[204:207]
    ds_read_b128 a[20:23], v14 offset:6912
    v_cvt_pk_bf16_f32 v57, v80, v82
    v_mfma_f32_16x16x32_bf16 v[208:211], a[72:75], a[24:27], v[208:211]
    v_lshlrev_b32 v80, 16, v43
    v_lshlrev_b32 v81, 16, v47
    v_mfma_f32_16x16x32_bf16 v[212:215], a[76:79], a[24:27], v[212:215]
    v_and_b32 v82, s36, v43
    v_and_b32 v83, s36, v47
    v_mfma_f32_16x16x32_bf16 v[216:219], a[68:71], a[28:31], v[216:219]
    ds_read_b128 a[24:27], v14 offset:9216
    v_add_f32 v66, v48, v49
    v_mfma_f32_16x16x32_bf16 v[220:223], a[72:75], a[28:31], v[220:223]
    v_add_f32 v58, v50, v51
    v_sub_f32 v48, v49, v48
    v_mfma_f32_16x16x32_bf16 v[224:227], a[76:79], a[28:31], v[224:227]
    v_sub_f32 v50, v51, v50
    s_waitcnt lgkmcnt(4)
    v_mfma_f32_16x16x32_bf16 v[228:231], a[68:71], a[0:3], v[228:231]
    ds_read_b128 a[28:31], v14 offset:11520
    v_add_f32 v67, v80, v81
    v_mfma_f32_16x16x32_bf16 v[232:235], a[72:75], a[0:3], v[232:235]
    v_add_f32 v59, v82, v83
    v_sub_f32 v80, v81, v80
    v_mfma_f32_16x16x32_bf16 v[236:239], a[76:79], a[0:3], v[236:239]
    v_sub_f32 v82, v83, v82
    v_cvt_pk_bf16_f32 v66, v66, v58
    v_mfma_f32_16x16x32_bf16 v[240:243], a[68:71], a[4:7], v[240:243]
    ds_read_b128 a[0:3], v14 offset:13824
    v_cvt_pk_bf16_f32 v58, v48, v50
    v_mfma_f32_16x16x32_bf16 v[244:247], a[72:75], a[4:7], v[244:247]
    v_cvt_pk_bf16_f32 v67, v67, v59
    v_cvt_pk_bf16_f32 v59, v80, v82
    v_mfma_f32_16x16x32_bf16 v[248:251], a[76:79], a[4:7], v[248:251]
    ds_read_b128 v[40:43], v27 offset:55296
    s_waitcnt vmcnt(18)
    v_mfma_f32_16x16x32_bf16 v[168:171], a[80:83], a[8:11], v[168:171]
    ds_read_b128 a[4:7], v15 offset:0
    s_mov_b32 s31, 258048
    v_mfma_f32_16x16x32_bf16 v[172:175], a[84:87], a[8:11], v[172:175]
    buffer_load_dwordx4 a[164:167], v28, s[20:23], s31 offen offset:0 sc1
    v_mfma_f32_16x16x32_bf16 v[176:179], a[88:91], a[8:11], v[176:179]
    ds_read_b128 v[44:47], v27 offset:39168
    s_barrier
    s_waitcnt lgkmcnt(6)
    v_mfma_f32_16x16x32_bf16 v[180:183], a[80:83], a[12:15], v[180:183]
    ds_read_b128 a[8:11], v15 offset:2304
    v_mfma_f32_16x16x32_bf16 v[184:187], a[84:87], a[12:15], v[184:187]
    buffer_load_dwordx4 a[168:171], v28, s[20:23], s31 offen offset:1024 sc1
    v_mfma_f32_16x16x32_bf16 v[188:191], a[88:91], a[12:15], v[188:191]
    ds_write_b64 v16, v[52:53] offset:32768
    v_mfma_f32_16x16x32_bf16 v[192:195], a[80:83], a[16:19], v[192:195]
    ds_read_b128 a[12:15], v15 offset:4608
    v_mfma_f32_16x16x32_bf16 v[196:199], a[84:87], a[16:19], v[196:199]
    buffer_load_dwordx4 a[172:175], v28, s[20:23], s31 offen offset:2048 sc1
    v_mfma_f32_16x16x32_bf16 v[200:203], a[88:91], a[16:19], v[200:203]
    s_mov_b32 s31, 688128
    v_mfma_f32_16x16x32_bf16 v[204:207], a[80:83], a[20:23], v[204:207]
    ds_read_b128 a[16:19], v15 offset:6912
    v_mfma_f32_16x16x32_bf16 v[208:211], a[84:87], a[20:23], v[208:211]
    buffer_load_dwordx4 a[176:179], v28, s[20:23], s31 offen offset:0 sc1
    v_mfma_f32_16x16x32_bf16 v[212:215], a[88:91], a[20:23], v[212:215]
    s_waitcnt lgkmcnt(7)
    v_mfma_f32_16x16x32_bf16 v[216:219], a[80:83], a[24:27], v[216:219]
    ds_read_b128 a[20:23], v15 offset:9216
    v_mfma_f32_16x16x32_bf16 v[220:223], a[84:87], a[24:27], v[220:223]
    buffer_load_dwordx4 a[180:183], v28, s[20:23], s31 offen offset:1024 sc1
    v_mfma_f32_16x16x32_bf16 v[224:227], a[88:91], a[24:27], v[224:227]
    ds_write_b64 v16, v[54:55] offset:32776
    v_mfma_f32_16x16x32_bf16 v[228:231], a[80:83], a[28:31], v[228:231]
    ds_read_b128 a[24:27], v15 offset:11520
    v_mfma_f32_16x16x32_bf16 v[232:235], a[84:87], a[28:31], v[232:235]
    buffer_load_dwordx4 a[184:187], v28, s[20:23], s31 offen offset:2048 sc1
    v_mfma_f32_16x16x32_bf16 v[236:239], a[88:91], a[28:31], v[236:239]
    ds_write_b64 v17, v[56:57] offset:32768
    v_mfma_f32_16x16x32_bf16 v[240:243], a[80:83], a[0:3], v[240:243]
    ds_read_b128 a[28:31], v15 offset:13824
    v_mfma_f32_16x16x32_bf16 v[244:247], a[84:87], a[0:3], v[244:247]
    ds_write_b64 v17, v[58:59] offset:32776
    v_lshlrev_b32 v48, 16, v32
    v_mfma_f32_16x16x32_bf16 v[248:251], a[88:91], a[0:3], v[248:251]
    s_waitcnt vmcnt(21)
    s_waitcnt lgkmcnt(7)
    v_mfma_f32_16x16x32_bf16 v[168:171], a[92:95], a[4:7], v[168:171]
    ds_read_b128 a[0:3], v10 offset:16384
    s_mov_b32 s31, 270336
    v_mfma_f32_16x16x32_bf16 v[172:175], a[96:99], a[4:7], v[172:175]
    buffer_load_dwordx4 a[188:191], v28, s[20:23], s31 offen offset:0 sc1
    v_lshlrev_b32 v49, 16, v36
    v_mfma_f32_16x16x32_bf16 v[176:179], a[100:103], a[4:7], v[176:179]
    v_and_b32 v50, s36, v32
    v_and_b32 v51, s36, v36
    v_mfma_f32_16x16x32_bf16 v[180:183], a[92:95], a[8:11], v[180:183]
    ds_read_b128 a[4:7], v10 offset:18688
    v_lshlrev_b32 v80, 16, v33
    v_mfma_f32_16x16x32_bf16 v[184:187], a[96:99], a[8:11], v[184:187]
    buffer_load_dwordx4 a[192:195], v28, s[20:23], s31 offen offset:1024 sc1
    v_lshlrev_b32 v81, 16, v37
    v_mfma_f32_16x16x32_bf16 v[188:191], a[100:103], a[8:11], v[188:191]
    v_and_b32 v82, s36, v33
    v_and_b32 v83, s36, v37
    v_mfma_f32_16x16x32_bf16 v[192:195], a[92:95], a[12:15], v[192:195]
    ds_read_b128 a[8:11], v10 offset:20992
    v_add_f32 v68, v48, v49
    v_mfma_f32_16x16x32_bf16 v[196:199], a[96:99], a[12:15], v[196:199]
    buffer_load_dwordx4 a[196:199], v28, s[20:23], s31 offen offset:2048 sc1
    v_add_f32 v52, v50, v51
    v_mfma_f32_16x16x32_bf16 v[200:203], a[100:103], a[12:15], v[200:203]
    v_sub_f32 v48, v49, v48
    s_waitcnt lgkmcnt(6)
    v_mfma_f32_16x16x32_bf16 v[204:207], a[92:95], a[16:19], v[204:207]
    ds_read_b128 a[12:15], v10 offset:23296
    v_sub_f32 v50, v51, v50
    v_mfma_f32_16x16x32_bf16 v[208:211], a[96:99], a[16:19], v[208:211]
    v_add_f32 v69, v80, v81
    v_add_f32 v53, v82, v83
    v_sub_f32 v80, v81, v80
    v_mfma_f32_16x16x32_bf16 v[212:215], a[100:103], a[16:19], v[212:215]
    v_sub_f32 v82, v83, v82
    v_cvt_pk_bf16_f32 v68, v68, v52
    v_mfma_f32_16x16x32_bf16 v[216:219], a[92:95], a[20:23], v[216:219]
    ds_read_b128 a[16:19], v10 offset:25600
    v_cvt_pk_bf16_f32 v52, v48, v50
    v_mfma_f32_16x16x32_bf16 v[220:223], a[96:99], a[20:23], v[220:223]
    v_lshlrev_b32 v48, 16, v34
    v_lshlrev_b32 v49, 16, v38
    v_and_b32 v50, s36, v34
    v_mfma_f32_16x16x32_bf16 v[224:227], a[100:103], a[20:23], v[224:227]
    v_and_b32 v51, s36, v38
    v_cvt_pk_bf16_f32 v69, v69, v53
    v_mfma_f32_16x16x32_bf16 v[228:231], a[92:95], a[24:27], v[228:231]
    ds_read_b128 a[20:23], v10 offset:27904
    v_cvt_pk_bf16_f32 v53, v80, v82
    v_mfma_f32_16x16x32_bf16 v[232:235], a[96:99], a[24:27], v[232:235]
    v_lshlrev_b32 v80, 16, v35
    v_lshlrev_b32 v81, 16, v39
    v_mfma_f32_16x16x32_bf16 v[236:239], a[100:103], a[24:27], v[236:239]
    v_and_b32 v82, s36, v35
    s_waitcnt lgkmcnt(4)
    v_mfma_f32_16x16x32_bf16 v[240:243], a[92:95], a[28:31], v[240:243]
    ds_read_b128 a[24:27], v10 offset:30208
    v_and_b32 v83, s36, v39
    v_mfma_f32_16x16x32_bf16 v[244:247], a[96:99], a[28:31], v[244:247]
    v_add_f32 v70, v48, v49
    v_add_f32 v54, v50, v51
    v_mfma_f32_16x16x32_bf16 v[248:251], a[100:103], a[28:31], v[248:251]
    v_sub_f32 v48, v49, v48
    s_waitcnt vmcnt(18)
    v_mfma_f32_16x16x32_bf16 v[84:87], a[116:119], a[0:3], v[84:87]
    ds_read_b128 a[28:31], v11 offset:16384
    s_mov_b32 s31, 282624
    v_mfma_f32_16x16x32_bf16 v[88:91], a[120:123], a[0:3], v[88:91]
    buffer_load_dwordx4 a[200:203], v28, s[20:23], s31 offen offset:0 sc1
    v_mfma_f32_16x16x32_bf16 v[92:95], a[124:127], a[0:3], v[92:95]
    v_sub_f32 v50, v51, v50
    v_add_f32 v71, v80, v81
    v_mfma_f32_16x16x32_bf16 v[96:99], a[116:119], a[4:7], v[96:99]
    ds_read_b128 a[0:3], v11 offset:18688
    v_add_f32 v55, v82, v83
    v_mfma_f32_16x16x32_bf16 v[100:103], a[120:123], a[4:7], v[100:103]
    buffer_load_dwordx4 a[204:207], v28, s[20:23], s31 offen offset:1024 sc1
    v_mfma_f32_16x16x32_bf16 v[104:107], a[124:127], a[4:7], v[104:107]
    v_sub_f32 v80, v81, v80
    s_waitcnt lgkmcnt(4)
    v_mfma_f32_16x16x32_bf16 v[108:111], a[116:119], a[8:11], v[108:111]
    ds_read_b128 a[4:7], v11 offset:20992
    v_sub_f32 v82, v83, v82
    v_mfma_f32_16x16x32_bf16 v[112:115], a[120:123], a[8:11], v[112:115]
    buffer_load_dwordx4 a[208:211], v28, s[20:23], s31 offen offset:2048 sc1
    v_mfma_f32_16x16x32_bf16 v[116:119], a[124:127], a[8:11], v[116:119]
    s_mov_b32 s31, 700416
    v_cvt_pk_bf16_f32 v70, v70, v54
    v_mfma_f32_16x16x32_bf16 v[120:123], a[116:119], a[12:15], v[120:123]
    ds_read_b128 a[8:11], v11 offset:23296
    v_cvt_pk_bf16_f32 v54, v48, v50
    v_mfma_f32_16x16x32_bf16 v[124:127], a[120:123], a[12:15], v[124:127]
    buffer_load_dwordx4 a[212:215], v28, s[20:23], s31 offen offset:0 sc1
    v_mfma_f32_16x16x32_bf16 v[128:131], a[124:127], a[12:15], v[128:131]
    v_cvt_pk_bf16_f32 v71, v71, v55
    v_cvt_pk_bf16_f32 v55, v80, v82
    v_mfma_f32_16x16x32_bf16 v[132:135], a[116:119], a[16:19], v[132:135]
    ds_read_b128 a[12:15], v11 offset:25600
    v_mfma_f32_16x16x32_bf16 v[136:139], a[120:123], a[16:19], v[136:139]
    buffer_load_dwordx4 a[216:219], v28, s[20:23], s31 offen offset:1024 sc1
    v_mfma_f32_16x16x32_bf16 v[140:143], a[124:127], a[16:19], v[140:143]
    s_waitcnt lgkmcnt(4)
    v_mfma_f32_16x16x32_bf16 v[144:147], a[116:119], a[20:23], v[144:147]
    ds_read_b128 a[16:19], v11 offset:27904
    v_mfma_f32_16x16x32_bf16 v[148:151], a[120:123], a[20:23], v[148:151]
    buffer_load_dwordx4 a[220:223], v28, s[20:23], s31 offen offset:2048 sc1
    v_mfma_f32_16x16x32_bf16 v[152:155], a[124:127], a[20:23], v[152:155]
    ds_write_b64 v18, v[52:53] offset:32768
    v_mfma_f32_16x16x32_bf16 v[156:159], a[116:119], a[24:27], v[156:159]
    ds_read_b128 a[20:23], v11 offset:30208
    v_mfma_f32_16x16x32_bf16 v[160:163], a[120:123], a[24:27], v[160:163]
    ds_write_b64 v18, v[54:55] offset:32776
    v_lshlrev_b32 v48, 16, v40
    v_mfma_f32_16x16x32_bf16 v[164:167], a[124:127], a[24:27], v[164:167]
    v_lshlrev_b32 v49, 16, v44
    s_waitcnt vmcnt(21)
    v_mfma_f32_16x16x32_bf16 v[84:87], a[128:131], a[28:31], v[84:87]
    ds_read_b128 a[24:27], v12 offset:16384
    s_mov_b32 s31, 294912
    v_mfma_f32_16x16x32_bf16 v[88:91], a[132:135], a[28:31], v[88:91]
    buffer_load_dwordx4 a[224:227], v28, s[20:23], s31 offen offset:0 sc1
    v_and_b32 v50, s36, v40
    v_mfma_f32_16x16x32_bf16 v[92:95], a[136:139], a[28:31], v[92:95]
    v_and_b32 v51, s36, v44
    s_waitcnt lgkmcnt(6)
    v_mfma_f32_16x16x32_bf16 v[96:99], a[128:131], a[0:3], v[96:99]
    ds_read_b128 a[28:31], v12 offset:18688
    v_lshlrev_b32 v80, 16, v41
    v_mfma_f32_16x16x32_bf16 v[100:103], a[132:135], a[0:3], v[100:103]
    buffer_load_dwordx4 a[228:231], v28, s[20:23], s31 offen offset:1024 sc1
    v_lshlrev_b32 v81, 16, v45
    v_mfma_f32_16x16x32_bf16 v[104:107], a[136:139], a[0:3], v[104:107]
    v_and_b32 v82, s36, v41
    v_and_b32 v83, s36, v45
    v_mfma_f32_16x16x32_bf16 v[108:111], a[128:131], a[4:7], v[108:111]
    ds_read_b128 a[0:3], v12 offset:20992
    v_add_f32 v72, v48, v49
    v_mfma_f32_16x16x32_bf16 v[112:115], a[132:135], a[4:7], v[112:115]
    buffer_load_dwordx4 a[232:235], v28, s[20:23], s31 offen offset:2048 sc1
    v_add_f32 v56, v50, v51
    v_mfma_f32_16x16x32_bf16 v[116:119], a[136:139], a[4:7], v[116:119]
    v_sub_f32 v48, v49, v48
    v_sub_f32 v50, v51, v50
    v_mfma_f32_16x16x32_bf16 v[120:123], a[128:131], a[8:11], v[120:123]
    ds_read_b128 a[4:7], v12 offset:23296
    v_add_f32 v73, v80, v81
    v_mfma_f32_16x16x32_bf16 v[124:127], a[132:135], a[8:11], v[124:127]
    v_add_f32 v57, v82, v83
    v_sub_f32 v80, v81, v80
    v_sub_f32 v82, v83, v82
    v_mfma_f32_16x16x32_bf16 v[128:131], a[136:139], a[8:11], v[128:131]
    v_cvt_pk_bf16_f32 v72, v72, v56
    s_waitcnt lgkmcnt(5)
    v_mfma_f32_16x16x32_bf16 v[132:135], a[128:131], a[12:15], v[132:135]
    ds_read_b128 a[8:11], v12 offset:25600
    v_cvt_pk_bf16_f32 v56, v48, v50
    v_mfma_f32_16x16x32_bf16 v[136:139], a[132:135], a[12:15], v[136:139]
    v_lshlrev_b32 v48, 16, v42
    v_lshlrev_b32 v49, 16, v46
    v_mfma_f32_16x16x32_bf16 v[140:143], a[136:139], a[12:15], v[140:143]
    v_and_b32 v50, s36, v42
    v_and_b32 v51, s36, v46
    v_mfma_f32_16x16x32_bf16 v[144:147], a[128:131], a[16:19], v[144:147]
    ds_read_b128 a[12:15], v12 offset:27904
    v_cvt_pk_bf16_f32 v73, v73, v57
    v_mfma_f32_16x16x32_bf16 v[148:151], a[132:135], a[16:19], v[148:151]
    v_cvt_pk_bf16_f32 v57, v80, v82
    v_lshlrev_b32 v80, 16, v43
    v_mfma_f32_16x16x32_bf16 v[152:155], a[136:139], a[16:19], v[152:155]
    v_lshlrev_b32 v81, 16, v47
    v_and_b32 v82, s36, v43
    v_mfma_f32_16x16x32_bf16 v[156:159], a[128:131], a[20:23], v[156:159]
    ds_read_b128 a[16:19], v12 offset:30208
    v_and_b32 v83, s36, v47
    v_mfma_f32_16x16x32_bf16 v[160:163], a[132:135], a[20:23], v[160:163]
    v_add_f32 v74, v48, v49
    v_add_f32 v58, v50, v51
    v_mfma_f32_16x16x32_bf16 v[164:167], a[136:139], a[20:23], v[164:167]
    s_waitcnt vmcnt(18)
    s_waitcnt lgkmcnt(4)
    v_mfma_f32_16x16x32_bf16 v[84:87], a[152:155], a[24:27], v[84:87]
    ds_read_b128 a[20:23], v13 offset:16384
    s_mov_b32 s31, 307200
    v_mfma_f32_16x16x32_bf16 v[88:91], a[156:159], a[24:27], v[88:91]
    buffer_load_dwordx4 a[236:239], v28, s[20:23], s31 offen offset:0 sc1
    v_mfma_f32_16x16x32_bf16 v[92:95], a[160:163], a[24:27], v[92:95]
    v_sub_f32 v48, v49, v48
    v_sub_f32 v50, v51, v50
    v_mfma_f32_16x16x32_bf16 v[96:99], a[152:155], a[28:31], v[96:99]
    ds_read_b128 a[24:27], v13 offset:18688
    v_add_f32 v75, v80, v81
    v_mfma_f32_16x16x32_bf16 v[100:103], a[156:159], a[28:31], v[100:103]
    buffer_load_dwordx4 a[240:243], v28, s[20:23], s31 offen offset:1024 sc1
    v_mfma_f32_16x16x32_bf16 v[104:107], a[160:163], a[28:31], v[104:107]
    v_add_f32 v59, v82, v83
    v_sub_f32 v80, v81, v80
    v_mfma_f32_16x16x32_bf16 v[108:111], a[152:155], a[0:3], v[108:111]
    ds_read_b128 a[28:31], v13 offset:20992
    v_sub_f32 v82, v83, v82
    v_mfma_f32_16x16x32_bf16 v[112:115], a[156:159], a[0:3], v[112:115]
    buffer_load_dwordx4 a[244:247], v28, s[20:23], s31 offen offset:2048 sc1
    v_mfma_f32_16x16x32_bf16 v[116:119], a[160:163], a[0:3], v[116:119]
    s_mov_b32 s31, 712704
    s_waitcnt lgkmcnt(4)
    v_mfma_f32_16x16x32_bf16 v[120:123], a[152:155], a[4:7], v[120:123]
    ds_read_b128 a[0:3], v13 offset:23296
    v_cvt_pk_bf16_f32 v74, v74, v58
    v_mfma_f32_16x16x32_bf16 v[124:127], a[156:159], a[4:7], v[124:127]
    buffer_load_dwordx4 a[32:35], v28, s[20:23], s31 offen offset:0 sc1
    v_mfma_f32_16x16x32_bf16 v[128:131], a[160:163], a[4:7], v[128:131]
    v_cvt_pk_bf16_f32 v58, v48, v50
    v_cvt_pk_bf16_f32 v75, v75, v59
    v_mfma_f32_16x16x32_bf16 v[132:135], a[152:155], a[8:11], v[132:135]
    ds_read_b128 a[4:7], v13 offset:25600
    v_cvt_pk_bf16_f32 v59, v80, v82
    v_mfma_f32_16x16x32_bf16 v[136:139], a[156:159], a[8:11], v[136:139]
    buffer_load_dwordx4 a[36:39], v28, s[20:23], s31 offen offset:1024 sc1
    v_mfma_f32_16x16x32_bf16 v[140:143], a[160:163], a[8:11], v[140:143]
    ds_write_b64 v19, v[56:57] offset:32768
    v_mfma_f32_16x16x32_bf16 v[144:147], a[152:155], a[12:15], v[144:147]
    ds_read_b128 a[8:11], v13 offset:27904
    v_mfma_f32_16x16x32_bf16 v[148:151], a[156:159], a[12:15], v[148:151]
    buffer_load_dwordx4 a[40:43], v28, s[20:23], s31 offen offset:2048 sc1
    v_mfma_f32_16x16x32_bf16 v[152:155], a[160:163], a[12:15], v[152:155]
    s_waitcnt lgkmcnt(5)
    v_mfma_f32_16x16x32_bf16 v[156:159], a[152:155], a[16:19], v[156:159]
    ds_read_b128 a[12:15], v13 offset:30208
    ds_write_b64 v19, v[58:59] offset:32776
    v_mfma_f32_16x16x32_bf16 v[160:163], a[156:159], a[16:19], v[160:163]
    v_mfma_f32_16x16x32_bf16 v[164:167], a[160:163], a[16:19], v[164:167]
    s_waitcnt vmcnt(21)
    v_mfma_f32_16x16x32_bf16 v[84:87], a[164:167], a[20:23], v[84:87]
    ds_read_b128 a[16:19], v14 offset:16384
    s_mov_b32 s31, 319488
    v_mfma_f32_16x16x32_bf16 v[88:91], a[168:171], a[20:23], v[88:91]
    buffer_load_dwordx4 a[44:47], v28, s[20:23], s31 offen offset:0 sc1
    v_mfma_f32_16x16x32_bf16 v[92:95], a[172:175], a[20:23], v[92:95]
    v_mfma_f32_16x16x32_bf16 v[96:99], a[164:167], a[24:27], v[96:99]
    ds_read_b128 a[20:23], v14 offset:18688
    v_mfma_f32_16x16x32_bf16 v[100:103], a[168:171], a[24:27], v[100:103]
    buffer_load_dwordx4 a[48:51], v28, s[20:23], s31 offen offset:1024 sc1
    v_mfma_f32_16x16x32_bf16 v[104:107], a[172:175], a[24:27], v[104:107]
    s_waitcnt lgkmcnt(6)
    v_mfma_f32_16x16x32_bf16 v[108:111], a[164:167], a[28:31], v[108:111]
    ds_read_b128 a[24:27], v14 offset:20992
    v_mfma_f32_16x16x32_bf16 v[112:115], a[168:171], a[28:31], v[112:115]
    buffer_load_dwordx4 a[52:55], v28, s[20:23], s31 offen offset:2048 sc1
    v_mfma_f32_16x16x32_bf16 v[116:119], a[172:175], a[28:31], v[116:119]
    s_waitcnt lgkmcnt(3)
    s_barrier
    v_mfma_f32_16x16x32_bf16 v[120:123], a[164:167], a[0:3], v[120:123]
    ds_read_b128 a[28:31], v14 offset:23296
    v_mfma_f32_16x16x32_bf16 v[124:127], a[168:171], a[0:3], v[124:127]
    ds_write_b64 v16, v[60:61] offset:0
    v_mfma_f32_16x16x32_bf16 v[128:131], a[172:175], a[0:3], v[128:131]
    ds_write_b64 v16, v[62:63] offset:8
    v_mfma_f32_16x16x32_bf16 v[132:135], a[164:167], a[4:7], v[132:135]
    ds_read_b128 a[0:3], v14 offset:25600
    v_mfma_f32_16x16x32_bf16 v[136:139], a[168:171], a[4:7], v[136:139]
    ds_write_b64 v17, v[64:65] offset:0
    v_mfma_f32_16x16x32_bf16 v[140:143], a[172:175], a[4:7], v[140:143]
    ds_write_b64 v17, v[66:67] offset:8
    v_mfma_f32_16x16x32_bf16 v[144:147], a[164:167], a[8:11], v[144:147]
    ds_read_b128 a[4:7], v14 offset:27904
    v_mfma_f32_16x16x32_bf16 v[148:151], a[168:171], a[8:11], v[148:151]
    ds_write_b64 v18, v[68:69] offset:0
    v_mfma_f32_16x16x32_bf16 v[152:155], a[172:175], a[8:11], v[152:155]
    ds_write_b64 v18, v[70:71] offset:8
    v_mfma_f32_16x16x32_bf16 v[156:159], a[164:167], a[12:15], v[156:159]
    ds_read_b128 a[8:11], v14 offset:30208
    v_mfma_f32_16x16x32_bf16 v[160:163], a[168:171], a[12:15], v[160:163]
    ds_write_b64 v19, v[72:73] offset:0
    v_mfma_f32_16x16x32_bf16 v[164:167], a[172:175], a[12:15], v[164:167]
    s_waitcnt vmcnt(18)
    s_waitcnt lgkmcnt(11)
    v_mfma_f32_16x16x32_bf16 v[84:87], a[188:191], a[16:19], v[84:87]
    ds_read_b128 a[12:15], v15 offset:16384
    s_mov_b32 s31, 331776
    v_mfma_f32_16x16x32_bf16 v[88:91], a[192:195], a[16:19], v[88:91]
    buffer_load_dwordx4 a[56:59], v28, s[20:23], s31 offen offset:0 sc1
    v_mfma_f32_16x16x32_bf16 v[92:95], a[196:199], a[16:19], v[92:95]
    ds_write_b64 v19, v[74:75] offset:8
    v_mfma_f32_16x16x32_bf16 v[96:99], a[188:191], a[20:23], v[96:99]
    ds_read_b128 a[16:19], v15 offset:18688
    ds_read_b128 v[32:35], v20 offset:36864
    v_mfma_f32_16x16x32_bf16 v[100:103], a[192:195], a[20:23], v[100:103]
    buffer_load_dwordx4 a[60:63], v28, s[20:23], s31 offen offset:1024 sc1
    v_mfma_f32_16x16x32_bf16 v[104:107], a[196:199], a[20:23], v[104:107]
    s_waitcnt lgkmcnt(13)
    ds_read_b128 v[36:39], v20 offset:39168
    ds_read_b128 v[40:43], v21 offset:36864
    v_mfma_f32_16x16x32_bf16 v[108:111], a[188:191], a[24:27], v[108:111]
    s_waitcnt lgkmcnt(13)
    ds_read_b128 a[20:23], v15 offset:20992
    ds_read_b128 v[44:47], v21 offset:39168
    v_mfma_f32_16x16x32_bf16 v[112:115], a[192:195], a[24:27], v[112:115]
    buffer_load_dwordx4 a[64:67], v28, s[20:23], s31 offen offset:2048 sc1
    v_mfma_f32_16x16x32_bf16 v[116:119], a[196:199], a[24:27], v[116:119]
    s_mov_b32 s31, 724992
    v_mfma_f32_16x16x32_bf16 v[120:123], a[188:191], a[28:31], v[120:123]
    s_waitcnt lgkmcnt(13)
    ds_read_b128 a[24:27], v15 offset:23296
    v_mfma_f32_16x16x32_bf16 v[124:127], a[192:195], a[28:31], v[124:127]
    buffer_load_dwordx4 a[68:71], v28, s[20:23], s31 offen offset:0 sc1
    v_mfma_f32_16x16x32_bf16 v[128:131], a[196:199], a[28:31], v[128:131]
    v_mfma_f32_16x16x32_bf16 v[132:135], a[188:191], a[0:3], v[132:135]
    ds_read_b128 a[28:31], v15 offset:25600
    v_mfma_f32_16x16x32_bf16 v[136:139], a[192:195], a[0:3], v[136:139]
    buffer_load_dwordx4 a[72:75], v28, s[20:23], s31 offen offset:1024 sc1
    v_mfma_f32_16x16x32_bf16 v[140:143], a[196:199], a[0:3], v[140:143]
    s_waitcnt lgkmcnt(9)
    v_mfma_f32_16x16x32_bf16 v[144:147], a[188:191], a[4:7], v[144:147]
    ds_read_b128 a[0:3], v15 offset:27904
    v_mfma_f32_16x16x32_bf16 v[148:151], a[192:195], a[4:7], v[148:151]
    buffer_load_dwordx4 a[76:79], v28, s[20:23], s31 offen offset:2048 sc1
    v_mfma_f32_16x16x32_bf16 v[152:155], a[196:199], a[4:7], v[152:155]
    s_waitcnt lgkmcnt(6)
    v_lshlrev_b32 v48, 16, v32
    v_mfma_f32_16x16x32_bf16 v[156:159], a[188:191], a[8:11], v[156:159]
    ds_read_b128 a[4:7], v15 offset:30208
    v_lshlrev_b32 v49, 16, v36
    v_mfma_f32_16x16x32_bf16 v[160:163], a[192:195], a[8:11], v[160:163]
    v_and_b32 v50, s36, v32
    v_and_b32 v51, s36, v36
    v_mfma_f32_16x16x32_bf16 v[164:167], a[196:199], a[8:11], v[164:167]
    v_lshlrev_b32 v80, 16, v33
    s_waitcnt vmcnt(21)
    v_mfma_f32_16x16x32_bf16 v[84:87], a[200:203], a[12:15], v[84:87]
    ds_read_b128 a[8:11], v10 offset:32768
    s_mov_b32 s31, 344064
    v_mfma_f32_16x16x32_bf16 v[88:91], a[204:207], a[12:15], v[88:91]
    buffer_load_dwordx4 a[80:83], v28, s[20:23], s31 offen offset:0 sc1
    v_mfma_f32_16x16x32_bf16 v[92:95], a[208:211], a[12:15], v[92:95]
    v_lshlrev_b32 v81, 16, v37
    v_sub_f32 v48, v48, v49
    v_mfma_f32_16x16x32_bf16 v[96:99], a[200:203], a[16:19], v[96:99]
    ds_read_b128 a[12:15], v10 offset:35072
    v_sub_f32 v50, v50, v51
    v_mfma_f32_16x16x32_bf16 v[100:103], a[204:207], a[16:19], v[100:103]
    buffer_load_dwordx4 a[84:87], v28, s[20:23], s31 offen offset:1024 sc1
    v_mfma_f32_16x16x32_bf16 v[104:107], a[208:211], a[16:19], v[104:107]
    v_and_b32 v82, s36, v33
    s_waitcnt lgkmcnt(4)
    v_mfma_f32_16x16x32_bf16 v[108:111], a[200:203], a[20:23], v[108:111]
    ds_read_b128 a[16:19], v10 offset:37376
    v_and_b32 v83, s36, v37
    v_mfma_f32_16x16x32_bf16 v[112:115], a[204:207], a[20:23], v[112:115]
    buffer_load_dwordx4 a[88:91], v28, s[20:23], s31 offen offset:2048 sc1
    v_mfma_f32_16x16x32_bf16 v[116:119], a[208:211], a[20:23], v[116:119]
    v_cvt_pk_bf16_f32 v52, v48, v50
    v_sub_f32 v80, v80, v81
    v_mfma_f32_16x16x32_bf16 v[120:123], a[200:203], a[24:27], v[120:123]
    ds_read_b128 a[20:23], v10 offset:39680
    v_lshlrev_b32 v48, 16, v34
    v_mfma_f32_16x16x32_bf16 v[124:127], a[204:207], a[24:27], v[124:127]
    v_sub_f32 v82, v82, v83
    v_lshlrev_b32 v49, 16, v38
    v_mfma_f32_16x16x32_bf16 v[128:131], a[208:211], a[24:27], v[128:131]
    v_and_b32 v50, s36, v34
    v_and_b32 v51, s36, v38
    v_mfma_f32_16x16x32_bf16 v[132:135], a[200:203], a[28:31], v[132:135]
    ds_read_b128 a[24:27], v10 offset:41984
    v_cvt_pk_bf16_f32 v53, v80, v82
    v_mfma_f32_16x16x32_bf16 v[136:139], a[204:207], a[28:31], v[136:139]
    v_lshlrev_b32 v80, 16, v35
    v_sub_f32 v48, v48, v49
    v_mfma_f32_16x16x32_bf16 v[140:143], a[208:211], a[28:31], v[140:143]
    v_lshlrev_b32 v81, 16, v39
    s_waitcnt lgkmcnt(4)
    v_mfma_f32_16x16x32_bf16 v[144:147], a[200:203], a[0:3], v[144:147]
    ds_read_b128 a[28:31], v10 offset:44288
    v_sub_f32 v50, v50, v51
    v_mfma_f32_16x16x32_bf16 v[148:151], a[204:207], a[0:3], v[148:151]
    v_and_b32 v82, s36, v35
    v_and_b32 v83, s36, v39
    v_mfma_f32_16x16x32_bf16 v[152:155], a[208:211], a[0:3], v[152:155]
    v_cvt_pk_bf16_f32 v54, v48, v50
    v_sub_f32 v80, v80, v81
    v_mfma_f32_16x16x32_bf16 v[156:159], a[200:203], a[4:7], v[156:159]
    ds_read_b128 a[0:3], v10 offset:46592
    v_sub_f32 v82, v82, v83
    v_mfma_f32_16x16x32_bf16 v[160:163], a[204:207], a[4:7], v[160:163]
    v_cvt_pk_bf16_f32 v55, v80, v82
    v_mfma_f32_16x16x32_bf16 v[164:167], a[208:211], a[4:7], v[164:167]
    s_waitcnt vmcnt(18)
    v_mfma_f32_16x16x32_bf16 v[168:171], a[224:227], a[8:11], v[168:171]
    ds_read_b128 a[4:7], v11 offset:32768
    s_mov_b32 s31, 356352
    v_mfma_f32_16x16x32_bf16 v[172:175], a[228:231], a[8:11], v[172:175]
    buffer_load_dwordx4 a[92:95], v28, s[20:23], s31 offen offset:0 sc1
    v_mfma_f32_16x16x32_bf16 v[176:179], a[232:235], a[8:11], v[176:179]
    s_waitcnt lgkmcnt(4)
    v_mfma_f32_16x16x32_bf16 v[180:183], a[224:227], a[12:15], v[180:183]
    ds_read_b128 a[8:11], v11 offset:35072
    v_mfma_f32_16x16x32_bf16 v[184:187], a[228:231], a[12:15], v[184:187]
    buffer_load_dwordx4 a[96:99], v28, s[20:23], s31 offen offset:1024 sc1
    v_mfma_f32_16x16x32_bf16 v[188:191], a[232:235], a[12:15], v[188:191]
    v_mfma_f32_16x16x32_bf16 v[192:195], a[224:227], a[16:19], v[192:195]
    ds_read_b128 a[12:15], v11 offset:37376
    v_mfma_f32_16x16x32_bf16 v[196:199], a[228:231], a[16:19], v[196:199]
    buffer_load_dwordx4 a[100:103], v28, s[20:23], s31 offen offset:2048 sc1
    v_mfma_f32_16x16x32_bf16 v[200:203], a[232:235], a[16:19], v[200:203]
    s_mov_b32 s31, 737280
    v_mfma_f32_16x16x32_bf16 v[204:207], a[224:227], a[20:23], v[204:207]
    ds_read_b128 a[16:19], v11 offset:39680
    v_mfma_f32_16x16x32_bf16 v[208:211], a[228:231], a[20:23], v[208:211]
    buffer_load_dwordx4 a[116:119], v28, s[20:23], s31 offen offset:0 sc1
    v_mfma_f32_16x16x32_bf16 v[212:215], a[232:235], a[20:23], v[212:215]
    s_waitcnt lgkmcnt(4)
    v_mfma_f32_16x16x32_bf16 v[216:219], a[224:227], a[24:27], v[216:219]
    ds_read_b128 a[20:23], v11 offset:41984
    v_mfma_f32_16x16x32_bf16 v[220:223], a[228:231], a[24:27], v[220:223]
    buffer_load_dwordx4 a[120:123], v28, s[20:23], s31 offen offset:1024 sc1
    v_mfma_f32_16x16x32_bf16 v[224:227], a[232:235], a[24:27], v[224:227]
    v_mfma_f32_16x16x32_bf16 v[228:231], a[224:227], a[28:31], v[228:231]
    ds_read_b128 a[24:27], v11 offset:44288
    v_mfma_f32_16x16x32_bf16 v[232:235], a[228:231], a[28:31], v[232:235]
    buffer_load_dwordx4 a[124:127], v28, s[20:23], s31 offen offset:2048 sc1
    v_mfma_f32_16x16x32_bf16 v[236:239], a[232:235], a[28:31], v[236:239]
    v_mfma_f32_16x16x32_bf16 v[240:243], a[224:227], a[0:3], v[240:243]
    ds_read_b128 a[28:31], v11 offset:46592
    v_mfma_f32_16x16x32_bf16 v[244:247], a[228:231], a[0:3], v[244:247]
    v_mfma_f32_16x16x32_bf16 v[248:251], a[232:235], a[0:3], v[248:251]
    s_waitcnt vmcnt(21)
    s_waitcnt lgkmcnt(4)
    v_mfma_f32_16x16x32_bf16 v[168:171], a[236:239], a[4:7], v[168:171]
    ds_read_b128 a[0:3], v12 offset:32768
    s_mov_b32 s31, 368640
    v_mfma_f32_16x16x32_bf16 v[172:175], a[240:243], a[4:7], v[172:175]
    buffer_load_dwordx4 a[128:131], v28, s[20:23], s31 offen offset:0 sc1
    v_mfma_f32_16x16x32_bf16 v[176:179], a[244:247], a[4:7], v[176:179]
    v_mfma_f32_16x16x32_bf16 v[180:183], a[236:239], a[8:11], v[180:183]
    ds_read_b128 a[4:7], v12 offset:35072
    v_mfma_f32_16x16x32_bf16 v[184:187], a[240:243], a[8:11], v[184:187]
    buffer_load_dwordx4 a[132:135], v28, s[20:23], s31 offen offset:1024 sc1
    v_mfma_f32_16x16x32_bf16 v[188:191], a[244:247], a[8:11], v[188:191]
    v_mfma_f32_16x16x32_bf16 v[192:195], a[236:239], a[12:15], v[192:195]
    ds_read_b128 a[8:11], v12 offset:37376
    v_mfma_f32_16x16x32_bf16 v[196:199], a[240:243], a[12:15], v[196:199]
    buffer_load_dwordx4 a[136:139], v28, s[20:23], s31 offen offset:2048 sc1
    v_mfma_f32_16x16x32_bf16 v[200:203], a[244:247], a[12:15], v[200:203]
    s_waitcnt lgkmcnt(4)
    v_mfma_f32_16x16x32_bf16 v[204:207], a[236:239], a[16:19], v[204:207]
    ds_read_b128 a[12:15], v12 offset:39680
    v_mfma_f32_16x16x32_bf16 v[208:211], a[240:243], a[16:19], v[208:211]
    v_mfma_f32_16x16x32_bf16 v[212:215], a[244:247], a[16:19], v[212:215]
    v_mfma_f32_16x16x32_bf16 v[216:219], a[236:239], a[20:23], v[216:219]
    ds_read_b128 a[16:19], v12 offset:41984
    v_mfma_f32_16x16x32_bf16 v[220:223], a[240:243], a[20:23], v[220:223]
    v_mfma_f32_16x16x32_bf16 v[224:227], a[244:247], a[20:23], v[224:227]
    v_mfma_f32_16x16x32_bf16 v[228:231], a[236:239], a[24:27], v[228:231]
    ds_read_b128 a[20:23], v12 offset:44288
    v_mfma_f32_16x16x32_bf16 v[232:235], a[240:243], a[24:27], v[232:235]
    v_mfma_f32_16x16x32_bf16 v[236:239], a[244:247], a[24:27], v[236:239]
    s_waitcnt lgkmcnt(4)
    v_mfma_f32_16x16x32_bf16 v[240:243], a[236:239], a[28:31], v[240:243]
    ds_read_b128 a[24:27], v12 offset:46592
    v_mfma_f32_16x16x32_bf16 v[244:247], a[240:243], a[28:31], v[244:247]
    v_mfma_f32_16x16x32_bf16 v[248:251], a[244:247], a[28:31], v[248:251]
    s_waitcnt vmcnt(18)
    v_mfma_f32_16x16x32_bf16 v[168:171], a[44:47], a[0:3], v[168:171]
    ds_read_b128 a[28:31], v13 offset:32768
    s_mov_b32 s31, 380928
    v_mfma_f32_16x16x32_bf16 v[172:175], a[48:51], a[0:3], v[172:175]
    buffer_load_dwordx4 a[152:155], v28, s[20:23], s31 offen offset:0 sc1
    v_mfma_f32_16x16x32_bf16 v[176:179], a[52:55], a[0:3], v[176:179]
    v_mfma_f32_16x16x32_bf16 v[180:183], a[44:47], a[4:7], v[180:183]
    ds_read_b128 a[0:3], v13 offset:35072
    v_mfma_f32_16x16x32_bf16 v[184:187], a[48:51], a[4:7], v[184:187]
    buffer_load_dwordx4 a[156:159], v28, s[20:23], s31 offen offset:1024 sc1
    v_mfma_f32_16x16x32_bf16 v[188:191], a[52:55], a[4:7], v[188:191]
    s_waitcnt lgkmcnt(4)
    v_mfma_f32_16x16x32_bf16 v[192:195], a[44:47], a[8:11], v[192:195]
    ds_read_b128 a[4:7], v13 offset:37376
    v_mfma_f32_16x16x32_bf16 v[196:199], a[48:51], a[8:11], v[196:199]
    buffer_load_dwordx4 a[160:163], v28, s[20:23], s31 offen offset:2048 sc1
    v_mfma_f32_16x16x32_bf16 v[200:203], a[52:55], a[8:11], v[200:203]
    s_mov_b32 s31, 749568
    v_mfma_f32_16x16x32_bf16 v[204:207], a[44:47], a[12:15], v[204:207]
    ds_read_b128 a[8:11], v13 offset:39680
L_pad3:
    s_cbranch_vccnz L_pad4
    v_mfma_f32_16x16x32_bf16 v[208:211], a[48:51], a[12:15], v[208:211]
    buffer_load_dwordx4 a[164:167], v28, s[20:23], s31 offen offset:0 sc1
    v_mfma_f32_16x16x32_bf16 v[212:215], a[52:55], a[12:15], v[212:215]
    v_mfma_f32_16x16x32_bf16 v[216:219], a[44:47], a[16:19], v[216:219]
    ds_read_b128 a[12:15], v13 offset:41984
    v_mfma_f32_16x16x32_bf16 v[220:223], a[48:51], a[16:19], v[220:223]
    buffer_load_dwordx4 a[168:171], v28, s[20:23], s31 offen offset:1024 sc1
    v_mfma_f32_16x16x32_bf16 v[224:227], a[52:55], a[16:19], v[224:227]
    s_waitcnt lgkmcnt(4)
    v_mfma_f32_16x16x32_bf16 v[228:231], a[44:47], a[20:23], v[228:231]
    ds_read_b128 a[16:19], v13 offset:44288
    v_mfma_f32_16x16x32_bf16 v[232:235], a[48:51], a[20:23], v[232:235]
    buffer_load_dwordx4 a[172:175], v28, s[20:23], s31 offen offset:2048 sc1
    v_mfma_f32_16x16x32_bf16 v[236:239], a[52:55], a[20:23], v[236:239]
    v_mfma_f32_16x16x32_bf16 v[240:243], a[44:47], a[24:27], v[240:243]
    ds_read_b128 a[20:23], v13 offset:46592
    v_mfma_f32_16x16x32_bf16 v[244:247], a[48:51], a[24:27], v[244:247]
    v_mfma_f32_16x16x32_bf16 v[248:251], a[52:55], a[24:27], v[248:251]
    s_barrier
    s_waitcnt vmcnt(21)
    v_mfma_f32_16x16x32_bf16 v[168:171], a[56:59], a[28:31], v[168:171]
    ds_read_b128 a[24:27], v14 offset:32768
    s_mov_b32 s31, 393216
    v_mfma_f32_16x16x32_bf16 v[172:175], a[60:63], a[28:31], v[172:175]
    buffer_load_dwordx4 a[188:191], v28, s[20:23], s31 offen offset:0 sc1
    v_mfma_f32_16x16x32_bf16 v[176:179], a[64:67], a[28:31], v[176:179]
    s_waitcnt lgkmcnt(4)
    v_mfma_f32_16x16x32_bf16 v[180:183], a[56:59], a[0:3], v[180:183]
    ds_read_b128 a[28:31], v14 offset:35072
    v_mfma_f32_16x16x32_bf16 v[184:187], a[60:63], a[0:3], v[184:187]
    buffer_load_dwordx4 a[192:195], v28, s[20:23], s31 offen offset:1024 sc1
    v_mfma_f32_16x16x32_bf16 v[188:191], a[64:67], a[0:3], v[188:191]
    ds_write_b64 v16, v[52:53] offset:16384
    v_mfma_f32_16x16x32_bf16 v[192:195], a[56:59], a[4:7], v[192:195]
    ds_read_b128 a[0:3], v14 offset:37376
    v_mfma_f32_16x16x32_bf16 v[196:199], a[60:63], a[4:7], v[196:199]
    buffer_load_dwordx4 a[196:199], v28, s[20:23], s31 offen offset:2048 sc1
    v_mfma_f32_16x16x32_bf16 v[200:203], a[64:67], a[4:7], v[200:203]
    ds_write_b64 v16, v[54:55] offset:16392
    v_mfma_f32_16x16x32_bf16 v[204:207], a[56:59], a[8:11], v[204:207]
    ds_read_b128 a[4:7], v14 offset:39680
    ds_read_b128 v[32:35], v22 offset:36864
    v_mfma_f32_16x16x32_bf16 v[208:211], a[60:63], a[8:11], v[208:211]
    ds_read_b128 v[36:39], v22 offset:39168
    v_lshlrev_b32 v48, 16, v40
    v_lshlrev_b32 v49, 16, v44
    v_mfma_f32_16x16x32_bf16 v[212:215], a[64:67], a[8:11], v[212:215]
    v_and_b32 v50, s36, v40
    s_waitcnt lgkmcnt(8)
    v_mfma_f32_16x16x32_bf16 v[216:219], a[56:59], a[12:15], v[216:219]
    ds_read_b128 a[8:11], v14 offset:41984
    v_and_b32 v51, s36, v44
    v_mfma_f32_16x16x32_bf16 v[220:223], a[60:63], a[12:15], v[220:223]
    v_lshlrev_b32 v80, 16, v41
    v_lshlrev_b32 v81, 16, v45
    v_sub_f32 v48, v48, v49
    v_mfma_f32_16x16x32_bf16 v[224:227], a[64:67], a[12:15], v[224:227]
    v_sub_f32 v50, v50, v51
    v_and_b32 v82, s36, v41
    v_mfma_f32_16x16x32_bf16 v[228:231], a[56:59], a[16:19], v[228:231]
    ds_read_b128 a[12:15], v14 offset:44288
    v_and_b32 v83, s36, v45
    v_mfma_f32_16x16x32_bf16 v[232:235], a[60:63], a[16:19], v[232:235]
    v_cvt_pk_bf16_f32 v56, v48, v50
    v_sub_f32 v80, v80, v81
    v_lshlrev_b32 v48, 16, v42
    v_mfma_f32_16x16x32_bf16 v[236:239], a[64:67], a[16:19], v[236:239]
    v_sub_f32 v82, v82, v83
    v_lshlrev_b32 v49, 16, v46
    v_mfma_f32_16x16x32_bf16 v[240:243], a[56:59], a[20:23], v[240:243]
    ds_read_b128 a[16:19], v14 offset:46592
    v_and_b32 v50, s36, v42
    v_mfma_f32_16x16x32_bf16 v[244:247], a[60:63], a[20:23], v[244:247]
    v_and_b32 v51, s36, v46
    v_cvt_pk_bf16_f32 v57, v80, v82
    v_lshlrev_b32 v80, 16, v43
    v_mfma_f32_16x16x32_bf16 v[248:251], a[64:67], a[20:23], v[248:251]
    s_waitcnt vmcnt(18)
    s_waitcnt lgkmcnt(7)
    v_mfma_f32_16x16x32_bf16 v[168:171], a[80:83], a[24:27], v[168:171]
    ds_read_b128 a[20:23], v15 offset:32768
    s_mov_b32 s31, 405504
    v_mfma_f32_16x16x32_bf16 v[172:175], a[84:87], a[24:27], v[172:175]
    buffer_load_dwordx4 a[200:203], v28, s[20:23], s31 offen offset:0 sc1
    v_sub_f32 v48, v48, v49
    v_mfma_f32_16x16x32_bf16 v[176:179], a[88:91], a[24:27], v[176:179]
    v_lshlrev_b32 v81, 16, v47
    v_sub_f32 v50, v50, v51
    v_mfma_f32_16x16x32_bf16 v[180:183], a[80:83], a[28:31], v[180:183]
    ds_read_b128 a[24:27], v15 offset:35072
    v_and_b32 v82, s36, v43
    v_mfma_f32_16x16x32_bf16 v[184:187], a[84:87], a[28:31], v[184:187]
    buffer_load_dwordx4 a[204:207], v28, s[20:23], s31 offen offset:1024 sc1
    v_and_b32 v83, s36, v47
    v_mfma_f32_16x16x32_bf16 v[188:191], a[88:91], a[28:31], v[188:191]
    v_cvt_pk_bf16_f32 v58, v48, v50
    v_sub_f32 v80, v80, v81
    v_mfma_f32_16x16x32_bf16 v[192:195], a[80:83], a[0:3], v[192:195]
    ds_read_b128 a[28:31], v15 offset:37376
    v_sub_f32 v82, v82, v83
    v_mfma_f32_16x16x32_bf16 v[196:199], a[84:87], a[0:3], v[196:199]
    buffer_load_dwordx4 a[208:211], v28, s[20:23], s31 offen offset:2048 sc1
    s_mov_b32 s31, 761856
    v_mfma_f32_16x16x32_bf16 v[200:203], a[88:91], a[0:3], v[200:203]
    v_cvt_pk_bf16_f32 v59, v80, v82
    s_waitcnt lgkmcnt(4)
    v_mfma_f32_16x16x32_bf16 v[204:207], a[80:83], a[4:7], v[204:207]
    ds_read_b128 a[0:3], v15 offset:39680
    v_mfma_f32_16x16x32_bf16 v[208:211], a[84:87], a[4:7], v[208:211]
    buffer_load_dwordx4 a[224:227], v28, s[20:23], s31 offen offset:0 sc1
    v_mfma_f32_16x16x32_bf16 v[212:215], a[88:91], a[4:7], v[212:215]
    ds_write_b64 v17, v[56:57] offset:16384
    v_mfma_f32_16x16x32_bf16 v[216:219], a[80:83], a[8:11], v[216:219]
    ds_read_b128 a[4:7], v15 offset:41984
    v_mfma_f32_16x16x32_bf16 v[220:223], a[84:87], a[8:11], v[220:223]
    buffer_load_dwordx4 a[228:231], v28, s[20:23], s31 offen offset:1024 sc1
    v_mfma_f32_16x16x32_bf16 v[224:227], a[88:91], a[8:11], v[224:227]
    ds_write_b64 v17, v[58:59] offset:16392
    v_mfma_f32_16x16x32_bf16 v[228:231], a[80:83], a[12:15], v[228:231]
    ds_read_b128 a[8:11], v15 offset:44288
    ds_read_b128 v[40:43], v23 offset:36864
    v_mfma_f32_16x16x32_bf16 v[232:235], a[84:87], a[12:15], v[232:235]
    buffer_load_dwordx4 a[232:235], v28, s[20:23], s31 offen offset:2048 sc1
    ds_read_b128 v[44:47], v23 offset:39168
    v_mfma_f32_16x16x32_bf16 v[236:239], a[88:91], a[12:15], v[236:239]
    v_lshlrev_b32 v48, 16, v32
    s_waitcnt lgkmcnt(8)
    v_mfma_f32_16x16x32_bf16 v[240:243], a[80:83], a[16:19], v[240:243]
    ds_read_b128 a[12:15], v15 offset:46592
    v_lshlrev_b32 v49, 16, v36
    v_mfma_f32_16x16x32_bf16 v[244:247], a[84:87], a[16:19], v[244:247]
    v_and_b32 v50, s36, v32
    v_and_b32 v51, s36, v36
    v_lshlrev_b32 v80, 16, v33
    v_mfma_f32_16x16x32_bf16 v[248:251], a[88:91], a[16:19], v[248:251]
    v_lshlrev_b32 v81, 16, v37
    s_waitcnt vmcnt(21)
    v_mfma_f32_16x16x32_bf16 v[168:171], a[92:95], a[20:23], v[168:171]
    ds_read_b128 a[16:19], v10 offset:0
    s_mov_b32 s31, 417792
    v_mfma_f32_16x16x32_bf16 v[172:175], a[96:99], a[20:23], v[172:175]
    buffer_load_dwordx4 a[236:239], v28, s[20:23], s31 offen offset:0 sc1
    v_sub_f32 v48, v48, v49
    v_mfma_f32_16x16x32_bf16 v[176:179], a[100:103], a[20:23], v[176:179]
    v_sub_f32 v50, v50, v51
    v_and_b32 v82, s36, v33
    v_mfma_f32_16x16x32_bf16 v[180:183], a[92:95], a[24:27], v[180:183]
    ds_read_b128 a[20:23], v10 offset:2304
    v_and_b32 v83, s36, v37
    v_mfma_f32_16x16x32_bf16 v[184:187], a[96:99], a[24:27], v[184:187]
    buffer_load_dwordx4 a[240:243], v28, s[20:23], s31 offen offset:1024 sc1
    v_cvt_pk_bf16_f32 v52, v48, v50
    v_mfma_f32_16x16x32_bf16 v[188:191], a[100:103], a[24:27], v[188:191]
    v_sub_f32 v80, v80, v81
    s_waitcnt lgkmcnt(7)
    v_mfma_f32_16x16x32_bf16 v[192:195], a[92:95], a[28:31], v[192:195]
    ds_read_b128 a[24:27], v10 offset:4608
    v_lshlrev_b32 v48, 16, v34
    v_mfma_f32_16x16x32_bf16 v[196:199], a[96:99], a[28:31], v[196:199]
    buffer_load_dwordx4 a[244:247], v28, s[20:23], s31 offen offset:2048 sc1
    v_sub_f32 v82, v82, v83
    v_mfma_f32_16x16x32_bf16 v[200:203], a[100:103], a[28:31], v[200:203]
    v_lshlrev_b32 v49, 16, v38
    v_and_b32 v50, s36, v34
    v_mfma_f32_16x16x32_bf16 v[204:207], a[92:95], a[0:3], v[204:207]
    ds_read_b128 a[28:31], v10 offset:6912
    v_and_b32 v51, s36, v38
    v_mfma_f32_16x16x32_bf16 v[208:211], a[96:99], a[0:3], v[208:211]
    v_cvt_pk_bf16_f32 v53, v80, v82
    v_lshlrev_b32 v80, 16, v35
    v_sub_f32 v48, v48, v49
    v_mfma_f32_16x16x32_bf16 v[212:215], a[100:103], a[0:3], v[212:215]
    v_lshlrev_b32 v81, 16, v39
    v_sub_f32 v50, v50, v51
    v_mfma_f32_16x16x32_bf16 v[216:219], a[92:95], a[4:7], v[216:219]
    ds_read_b128 a[0:3], v10 offset:9216
    v_and_b32 v82, s36, v35
    v_mfma_f32_16x16x32_bf16 v[220:223], a[96:99], a[4:7], v[220:223]
    v_and_b32 v83, s36, v39
    v_cvt_pk_bf16_f32 v54, v48, v50
    v_sub_f32 v80, v80, v81
    v_mfma_f32_16x16x32_bf16 v[224:227], a[100:103], a[4:7], v[224:227]
    v_sub_f32 v82, v82, v83
    s_waitcnt lgkmcnt(4)
    v_mfma_f32_16x16x32_bf16 v[228:231], a[92:95], a[8:11], v[228:231]
    ds_read_b128 a[4:7], v10 offset:11520
    v_cvt_pk_bf16_f32 v55, v80, v82
    v_mfma_f32_16x16x32_bf16 v[232:235], a[96:99], a[8:11], v[232:235]
    ds_write_b64 v18, v[52:53] offset:16384
    v_mfma_f32_16x16x32_bf16 v[236:239], a[100:103], a[8:11], v[236:239]
    ds_write_b64 v18, v[54:55] offset:16392
    v_mfma_f32_16x16x32_bf16 v[240:243], a[92:95], a[12:15], v[240:243]
    ds_read_b128 a[8:11], v10 offset:13824
    ds_read_b128 v[32:35], v24 offset:36864
    v_mfma_f32_16x16x32_bf16 v[244:247], a[96:99], a[12:15], v[244:247]
    ds_read_b128 v[36:39], v24 offset:39168
    v_lshlrev_b32 v48, 16, v40
    v_mfma_f32_16x16x32_bf16 v[248:251], a[100:103], a[12:15], v[248:251]
    v_lshlrev_b32 v49, 16, v44
    s_waitcnt vmcnt(18)
    v_mfma_f32_16x16x32_bf16 v[84:87], a[128:131], a[16:19], v[84:87]
    ds_read_b128 a[12:15], v11 offset:0
    s_mov_b32 s31, 430080
    v_mfma_f32_16x16x32_bf16 v[88:91], a[132:135], a[16:19], v[88:91]
    buffer_load_dwordx4 a[44:47], v28, s[20:23], s31 offen offset:0 sc1
    v_mfma_f32_16x16x32_bf16 v[92:95], a[136:139], a[16:19], v[92:95]
    v_and_b32 v50, s36, v40
    s_waitcnt lgkmcnt(8)
    v_mfma_f32_16x16x32_bf16 v[96:99], a[128:131], a[20:23], v[96:99]
    ds_read_b128 a[16:19], v11 offset:2304
    v_and_b32 v51, s36, v44
    v_mfma_f32_16x16x32_bf16 v[100:103], a[132:135], a[20:23], v[100:103]
    buffer_load_dwordx4 a[48:51], v28, s[20:23], s31 offen offset:1024 sc1
    v_mfma_f32_16x16x32_bf16 v[104:107], a[136:139], a[20:23], v[104:107]
    v_lshlrev_b32 v80, 16, v41
    v_lshlrev_b32 v81, 16, v45
    v_mfma_f32_16x16x32_bf16 v[108:111], a[128:131], a[24:27], v[108:111]
    ds_read_b128 a[20:23], v11 offset:4608
    v_sub_f32 v48, v48, v49
    v_mfma_f32_16x16x32_bf16 v[112:115], a[132:135], a[24:27], v[112:115]
    buffer_load_dwordx4 a[52:55], v28, s[20:23], s31 offen offset:2048 sc1
    v_mfma_f32_16x16x32_bf16 v[116:119], a[136:139], a[24:27], v[116:119]
    s_mov_b32 s31, 774144
    v_sub_f32 v50, v50, v51
    v_mfma_f32_16x16x32_bf16 v[120:123], a[128:131], a[28:31], v[120:123]
    ds_read_b128 a[24:27], v11 offset:6912
    v_and_b32 v82, s36, v41
    v_mfma_f32_16x16x32_bf16 v[124:127], a[132:135], a[28:31], v[124:127]
    buffer_load_dwordx4 a[56:59], v28, s[20:23], s31 offen offset:0 sc1
    v_mfma_f32_16x16x32_bf16 v[128:131], a[136:139], a[28:31], v[128:131]
    v_and_b32 v83, s36, v45
    s_waitcnt lgkmcnt(6)
    v_mfma_f32_16x16x32_bf16 v[132:135], a[128:131], a[0:3], v[132:135]
    ds_read_b128 a[28:31], v11 offset:9216
    v_cvt_pk_bf16_f32 v56, v48, v50
    v_mfma_f32_16x16x32_bf16 v[136:139], a[132:135], a[0:3], v[136:139]
    buffer_load_dwordx4 a[60:63], v28, s[20:23], s31 offen offset:1024 sc1
    v_mfma_f32_16x16x32_bf16 v[140:143], a[136:139], a[0:3], v[140:143]
    v_sub_f32 v80, v80, v81
    v_lshlrev_b32 v48, 16, v42
    v_mfma_f32_16x16x32_bf16 v[144:147], a[128:131], a[4:7], v[144:147]
    ds_read_b128 a[0:3], v11 offset:11520
    v_sub_f32 v82, v82, v83
    v_mfma_f32_16x16x32_bf16 v[148:151], a[132:135], a[4:7], v[148:151]
    buffer_load_dwordx4 a[64:67], v28, s[20:23], s31 offen offset:2048 sc1
    v_mfma_f32_16x16x32_bf16 v[152:155], a[136:139], a[4:7], v[152:155]
    v_lshlrev_b32 v49, 16, v46
    v_and_b32 v50, s36, v42
    v_mfma_f32_16x16x32_bf16 v[156:159], a[128:131], a[8:11], v[156:159]
    ds_read_b128 a[4:7], v11 offset:13824
    v_and_b32 v51, s36, v46
    v_mfma_f32_16x16x32_bf16 v[160:163], a[132:135], a[8:11], v[160:163]
    v_cvt_pk_bf16_f32 v57, v80, v82
    v_lshlrev_b32 v80, 16, v43
    v_mfma_f32_16x16x32_bf16 v[164:167], a[136:139], a[8:11], v[164:167]
    s_waitcnt vmcnt(21)
    s_waitcnt lgkmcnt(4)
    v_mfma_f32_16x16x32_bf16 v[84:87], a[152:155], a[12:15], v[84:87]
    ds_read_b128 a[8:11], v12 offset:0
    s_mov_b32 s31, 442368
    v_mfma_f32_16x16x32_bf16 v[88:91], a[156:159], a[12:15], v[88:91]
    buffer_load_dwordx4 a[80:83], v28, s[20:23], s31 offen offset:0 sc1
    v_sub_f32 v48, v48, v49
    v_mfma_f32_16x16x32_bf16 v[92:95], a[160:163], a[12:15], v[92:95]
    v_lshlrev_b32 v81, 16, v47
    v_sub_f32 v50, v50, v51
    v_mfma_f32_16x16x32_bf16 v[96:99], a[152:155], a[16:19], v[96:99]
    ds_read_b128 a[12:15], v12 offset:2304
    v_and_b32 v82, s36, v43
    v_mfma_f32_16x16x32_bf16 v[100:103], a[156:159], a[16:19], v[100:103]
    buffer_load_dwordx4 a[84:87], v28, s[20:23], s31 offen offset:1024 sc1
    v_mfma_f32_16x16x32_bf16 v[104:107], a[160:163], a[16:19], v[104:107]
    v_and_b32 v83, s36, v47
    v_cvt_pk_bf16_f32 v58, v48, v50
    v_mfma_f32_16x16x32_bf16 v[108:111], a[152:155], a[20:23], v[108:111]
    ds_read_b128 a[16:19], v12 offset:4608
    v_sub_f32 v80, v80, v81
    v_mfma_f32_16x16x32_bf16 v[112:115], a[156:159], a[20:23], v[112:115]
    buffer_load_dwordx4 a[88:91], v28, s[20:23], s31 offen offset:2048 sc1
    v_mfma_f32_16x16x32_bf16 v[116:119], a[160:163], a[20:23], v[116:119]
    v_sub_f32 v82, v82, v83
    s_waitcnt lgkmcnt(4)
    v_mfma_f32_16x16x32_bf16 v[120:123], a[152:155], a[24:27], v[120:123]
    ds_read_b128 a[20:23], v12 offset:6912
    v_cvt_pk_bf16_f32 v59, v80, v82
    ds_write_b64 v19, v[56:57] offset:16384
    v_mfma_f32_16x16x32_bf16 v[124:127], a[156:159], a[24:27], v[124:127]
    ds_write_b64 v19, v[58:59] offset:16392
    v_mfma_f32_16x16x32_bf16 v[128:131], a[160:163], a[24:27], v[128:131]
    ds_read_b128 v[40:43], v25 offset:36864
    ds_read_b128 v[44:47], v25 offset:39168
    v_mfma_f32_16x16x32_bf16 v[132:135], a[152:155], a[28:31], v[132:135]
    ds_read_b128 a[24:27], v12 offset:9216
    v_lshlrev_b32 v48, 16, v32
    v_mfma_f32_16x16x32_bf16 v[136:139], a[156:159], a[28:31], v[136:139]
    v_lshlrev_b32 v49, 16, v36
    v_and_b32 v50, s36, v32
    v_and_b32 v51, s36, v36
    v_mfma_f32_16x16x32_bf16 v[140:143], a[160:163], a[28:31], v[140:143]
    v_lshlrev_b32 v80, 16, v33
    v_lshlrev_b32 v81, 16, v37
    v_mfma_f32_16x16x32_bf16 v[144:147], a[152:155], a[0:3], v[144:147]
    ds_read_b128 a[28:31], v12 offset:11520
    v_sub_f32 v48, v48, v49
    v_mfma_f32_16x16x32_bf16 v[148:151], a[156:159], a[0:3], v[148:151]
    v_sub_f32 v50, v50, v51
    v_and_b32 v82, s36, v33
    v_and_b32 v83, s36, v37
    v_mfma_f32_16x16x32_bf16 v[152:155], a[160:163], a[0:3], v[152:155]
    v_cvt_pk_bf16_f32 v52, v48, v50
    s_waitcnt lgkmcnt(8)
    v_mfma_f32_16x16x32_bf16 v[156:159], a[152:155], a[4:7], v[156:159]
    ds_read_b128 a[0:3], v12 offset:13824
    v_sub_f32 v80, v80, v81
    v_mfma_f32_16x16x32_bf16 v[160:163], a[156:159], a[4:7], v[160:163]
    v_lshlrev_b32 v48, 16, v34
    v_sub_f32 v82, v82, v83
    v_lshlrev_b32 v49, 16, v38
    v_mfma_f32_16x16x32_bf16 v[164:167], a[160:163], a[4:7], v[164:167]
    v_and_b32 v50, s36, v34
    s_waitcnt vmcnt(18)
    v_mfma_f32_16x16x32_bf16 v[84:87], a[188:191], a[8:11], v[84:87]
    ds_read_b128 a[4:7], v13 offset:0
    s_mov_b32 s31, 454656
    v_mfma_f32_16x16x32_bf16 v[88:91], a[192:195], a[8:11], v[88:91]
    buffer_load_dwordx4 a[92:95], v28, s[20:23], s31 offen offset:0 sc1
    v_and_b32 v51, s36, v38
    v_mfma_f32_16x16x32_bf16 v[92:95], a[196:199], a[8:11], v[92:95]
    v_cvt_pk_bf16_f32 v53, v80, v82
    v_lshlrev_b32 v80, 16, v35
    s_waitcnt lgkmcnt(6)
    s_barrier
    v_mfma_f32_16x16x32_bf16 v[96:99], a[188:191], a[12:15], v[96:99]
    ds_read_b128 a[8:11], v13 offset:2304
    v_sub_f32 v48, v48, v49
    v_mfma_f32_16x16x32_bf16 v[100:103], a[192:195], a[12:15], v[100:103]
    buffer_load_dwordx4 a[96:99], v28, s[20:23], s31 offen offset:1024 sc1
    v_lshlrev_b32 v81, 16, v39
    v_mfma_f32_16x16x32_bf16 v[104:107], a[196:199], a[12:15], v[104:107]
    v_sub_f32 v50, v50, v51
    v_and_b32 v82, s36, v35
    v_mfma_f32_16x16x32_bf16 v[108:111], a[188:191], a[16:19], v[108:111]
    ds_read_b128 a[12:15], v13 offset:4608
    v_and_b32 v83, s36, v39
    v_mfma_f32_16x16x32_bf16 v[112:115], a[192:195], a[16:19], v[112:115]
    buffer_load_dwordx4 a[100:103], v28, s[20:23], s31 offen offset:2048 sc1
    s_mov_b32 s31, 786432
    v_mfma_f32_16x16x32_bf16 v[116:119], a[196:199], a[16:19], v[116:119]
    v_cvt_pk_bf16_f32 v54, v48, v50
    v_sub_f32 v80, v80, v81
    v_mfma_f32_16x16x32_bf16 v[120:123], a[188:191], a[20:23], v[120:123]
    ds_read_b128 a[16:19], v13 offset:6912
    v_sub_f32 v82, v82, v83
    v_mfma_f32_16x16x32_bf16 v[124:127], a[192:195], a[20:23], v[124:127]
    buffer_load_dwordx4 a[128:131], v28, s[20:23], s31 offen offset:0 sc1
    v_cvt_pk_bf16_f32 v55, v80, v82
    v_mfma_f32_16x16x32_bf16 v[128:131], a[196:199], a[20:23], v[128:131]
    s_waitcnt lgkmcnt(4)
    v_mfma_f32_16x16x32_bf16 v[132:135], a[188:191], a[24:27], v[132:135]
    ds_read_b128 a[20:23], v13 offset:9216
    v_mfma_f32_16x16x32_bf16 v[136:139], a[192:195], a[24:27], v[136:139]
    buffer_load_dwordx4 a[132:135], v28, s[20:23], s31 offen offset:1024 sc1
    v_mfma_f32_16x16x32_bf16 v[140:143], a[196:199], a[24:27], v[140:143]
    ds_write_b64 v16, v[52:53] offset:32768
    v_mfma_f32_16x16x32_bf16 v[144:147], a[188:191], a[28:31], v[144:147]
    ds_read_b128 a[24:27], v13 offset:11520
    v_mfma_f32_16x16x32_bf16 v[148:151], a[192:195], a[28:31], v[148:151]
    buffer_load_dwordx4 a[136:139], v28, s[20:23], s31 offen offset:2048 sc1
    v_mfma_f32_16x16x32_bf16 v[152:155], a[196:199], a[28:31], v[152:155]
    ds_write_b64 v16, v[54:55] offset:32776
    v_mfma_f32_16x16x32_bf16 v[156:159], a[188:191], a[0:3], v[156:159]
    ds_read_b128 a[28:31], v13 offset:13824
    ds_read_b128 v[32:35], v26 offset:36864
    v_mfma_f32_16x16x32_bf16 v[160:163], a[192:195], a[0:3], v[160:163]
    ds_read_b128 v[36:39], v26 offset:39168
    v_lshlrev_b32 v48, 16, v40
    v_lshlrev_b32 v49, 16, v44
    v_mfma_f32_16x16x32_bf16 v[164:167], a[196:199], a[0:3], v[164:167]
    s_waitcnt vmcnt(21)
    s_waitcnt lgkmcnt(8)
    v_mfma_f32_16x16x32_bf16 v[84:87], a[200:203], a[4:7], v[84:87]
    ds_read_b128 a[0:3], v14 offset:0
    s_mov_b32 s31, 466944
    v_mfma_f32_16x16x32_bf16 v[88:91], a[204:207], a[4:7], v[88:91]
    buffer_load_dwordx4 a[152:155], v28, s[20:23], s31 offen offset:0 sc1
    v_and_b32 v50, s36, v40
    v_mfma_f32_16x16x32_bf16 v[92:95], a[208:211], a[4:7], v[92:95]
    v_and_b32 v51, s36, v44
    v_lshlrev_b32 v80, 16, v41
    v_mfma_f32_16x16x32_bf16 v[96:99], a[200:203], a[8:11], v[96:99]
    ds_read_b128 a[4:7], v14 offset:2304
    v_lshlrev_b32 v81, 16, v45
    v_mfma_f32_16x16x32_bf16 v[100:103], a[204:207], a[8:11], v[100:103]
    buffer_load_dwordx4 a[156:159], v28, s[20:23], s31 offen offset:1024 sc1
    v_sub_f32 v48, v48, v49
    v_mfma_f32_16x16x32_bf16 v[104:107], a[208:211], a[8:11], v[104:107]
    v_sub_f32 v50, v50, v51
    v_and_b32 v82, s36, v41
    v_mfma_f32_16x16x32_bf16 v[108:111], a[200:203], a[12:15], v[108:111]
    ds_read_b128 a[8:11], v14 offset:4608
    v_and_b32 v83, s36, v45
    v_mfma_f32_16x16x32_bf16 v[112:115], a[204:207], a[12:15], v[112:115]
    buffer_load_dwordx4 a[160:163], v28, s[20:23], s31 offen offset:2048 sc1
    v_cvt_pk_bf16_f32 v56, v48, v50
    v_mfma_f32_16x16x32_bf16 v[116:119], a[208:211], a[12:15], v[116:119]
    v_sub_f32 v80, v80, v81
    s_waitcnt lgkmcnt(7)
    v_mfma_f32_16x16x32_bf16 v[120:123], a[200:203], a[16:19], v[120:123]
    ds_read_b128 a[12:15], v14 offset:6912
    v_lshlrev_b32 v48, 16, v42
    v_mfma_f32_16x16x32_bf16 v[124:127], a[204:207], a[16:19], v[124:127]
    v_sub_f32 v82, v82, v83
    v_lshlrev_b32 v49, 16, v46
    v_and_b32 v50, s36, v42
    v_mfma_f32_16x16x32_bf16 v[128:131], a[208:211], a[16:19], v[128:131]
    v_and_b32 v51, s36, v46
    v_cvt_pk_bf16_f32 v57, v80, v82
    v_mfma_f32_16x16x32_bf16 v[132:135], a[200:203], a[20:23], v[132:135]
    ds_read_b128 a[16:19], v14 offset:9216
    v_lshlrev_b32 v80, 16, v43
    v_mfma_f32_16x16x32_bf16 v[136:139], a[204:207], a[20:23], v[136:139]
    v_sub_f32 v48, v48, v49
    v_lshlrev_b32 v81, 16, v47
    v_sub_f32 v50, v50, v51
    v_mfma_f32_16x16x32_bf16 v[140:143], a[208:211], a[20:23], v[140:143]
    v_and_b32 v82, s36, v43
    v_and_b32 v83, s36, v47
    v_mfma_f32_16x16x32_bf16 v[144:147], a[200:203], a[24:27], v[144:147]
    ds_read_b128 a[20:23], v14 offset:11520
    v_cvt_pk_bf16_f32 v58, v48, v50
    v_mfma_f32_16x16x32_bf16 v[148:151], a[204:207], a[24:27], v[148:151]
    v_sub_f32 v80, v80, v81
    v_sub_f32 v82, v82, v83
    v_cvt_pk_bf16_f32 v59, v80, v82
    v_mfma_f32_16x16x32_bf16 v[152:155], a[208:211], a[24:27], v[152:155]
    s_waitcnt lgkmcnt(4)
    v_mfma_f32_16x16x32_bf16 v[156:159], a[200:203], a[28:31], v[156:159]
    ds_read_b128 a[24:27], v14 offset:13824
    v_mfma_f32_16x16x32_bf16 v[160:163], a[204:207], a[28:31], v[160:163]
    ds_write_b64 v17, v[56:57] offset:32768
    v_mfma_f32_16x16x32_bf16 v[164:167], a[208:211], a[28:31], v[164:167]
    s_waitcnt vmcnt(18)
    v_mfma_f32_16x16x32_bf16 v[84:87], a[236:239], a[0:3], v[84:87]
    ds_read_b128 a[28:31], v15 offset:0
    s_mov_b32 s31, 479232
    v_mfma_f32_16x16x32_bf16 v[88:91], a[240:243], a[0:3], v[88:91]
    buffer_load_dwordx4 a[188:191], v28, s[20:23], s31 offen offset:0 sc1
    v_mfma_f32_16x16x32_bf16 v[92:95], a[244:247], a[0:3], v[92:95]
    ds_write_b64 v17, v[58:59] offset:32776
    v_mfma_f32_16x16x32_bf16 v[96:99], a[236:239], a[4:7], v[96:99]
    ds_read_b128 a[0:3], v15 offset:2304
    ds_read_b128 v[40:43], v27 offset:36864
    v_mfma_f32_16x16x32_bf16 v[100:103], a[240:243], a[4:7], v[100:103]
    buffer_load_dwordx4 a[192:195], v28, s[20:23], s31 offen offset:1024 sc1
    ds_read_b128 v[44:47], v27 offset:39168
    v_mfma_f32_16x16x32_bf16 v[104:107], a[244:247], a[4:7], v[104:107]
    v_lshlrev_b32 v48, 16, v32
    s_waitcnt lgkmcnt(8)
    v_mfma_f32_16x16x32_bf16 v[108:111], a[236:239], a[8:11], v[108:111]
    ds_read_b128 a[4:7], v15 offset:4608
    v_lshlrev_b32 v49, 16, v36
    v_mfma_f32_16x16x32_bf16 v[112:115], a[240:243], a[8:11], v[112:115]
    buffer_load_dwordx4 a[196:199], v28, s[20:23], s31 offen offset:2048 sc1
    s_mov_b32 s31, 798720
    v_mfma_f32_16x16x32_bf16 v[116:119], a[244:247], a[8:11], v[116:119]
    v_and_b32 v50, s36, v32
    v_and_b32 v51, s36, v36
    v_mfma_f32_16x16x32_bf16 v[120:123], a[236:239], a[12:15], v[120:123]
    ds_read_b128 a[8:11], v15 offset:6912
    v_lshlrev_b32 v80, 16, v33
    v_mfma_f32_16x16x32_bf16 v[124:127], a[240:243], a[12:15], v[124:127]
    buffer_load_dwordx4 a[200:203], v28, s[20:23], s31 offen offset:0 sc1
    v_lshlrev_b32 v81, 16, v37
    v_mfma_f32_16x16x32_bf16 v[128:131], a[244:247], a[12:15], v[128:131]
    v_sub_f32 v48, v48, v49
    v_sub_f32 v50, v50, v51
    v_mfma_f32_16x16x32_bf16 v[132:135], a[236:239], a[16:19], v[132:135]
    ds_read_b128 a[12:15], v15 offset:9216
    v_and_b32 v82, s36, v33
    v_mfma_f32_16x16x32_bf16 v[136:139], a[240:243], a[16:19], v[136:139]
    buffer_load_dwordx4 a[204:207], v28, s[20:23], s31 offen offset:1024 sc1
    v_and_b32 v83, s36, v37
    v_mfma_f32_16x16x32_bf16 v[140:143], a[244:247], a[16:19], v[140:143]
    v_cvt_pk_bf16_f32 v52, v48, v50
    s_waitcnt lgkmcnt(7)
    v_mfma_f32_16x16x32_bf16 v[144:147], a[236:239], a[20:23], v[144:147]
    ds_read_b128 a[16:19], v15 offset:11520
    v_sub_f32 v80, v80, v81
    v_mfma_f32_16x16x32_bf16 v[148:151], a[240:243], a[20:23], v[148:151]
    buffer_load_dwordx4 a[208:211], v28, s[20:23], s31 offen offset:2048 sc1
    v_lshlrev_b32 v48, 16, v34
    v_mfma_f32_16x16x32_bf16 v[152:155], a[244:247], a[20:23], v[152:155]
    v_sub_f32 v82, v82, v83
    v_lshlrev_b32 v49, 16, v38
    v_mfma_f32_16x16x32_bf16 v[156:159], a[236:239], a[24:27], v[156:159]
    ds_read_b128 a[20:23], v15 offset:13824
    v_and_b32 v50, s36, v34
    v_mfma_f32_16x16x32_bf16 v[160:163], a[240:243], a[24:27], v[160:163]
    v_and_b32 v51, s36, v38
    v_cvt_pk_bf16_f32 v53, v80, v82
    v_lshlrev_b32 v80, 16, v35
    v_mfma_f32_16x16x32_bf16 v[164:167], a[244:247], a[24:27], v[164:167]
    v_sub_f32 v48, v48, v49
    s_waitcnt vmcnt(21)
    v_mfma_f32_16x16x32_bf16 v[84:87], a[44:47], a[28:31], v[84:87]
    ds_read_b128 a[24:27], v10 offset:16384
    s_mov_b32 s31, 491520
    v_mfma_f32_16x16x32_bf16 v[88:91], a[48:51], a[28:31], v[88:91]
    buffer_load_dwordx4 a[236:239], v28, s[20:23], s31 offen offset:0 sc1
    v_lshlrev_b32 v81, 16, v39
    v_mfma_f32_16x16x32_bf16 v[92:95], a[52:55], a[28:31], v[92:95]
    v_sub_f32 v50, v50, v51
    s_waitcnt lgkmcnt(4)
    v_mfma_f32_16x16x32_bf16 v[96:99], a[44:47], a[0:3], v[96:99]
    ds_read_b128 a[28:31], v10 offset:18688
    v_and_b32 v82, s36, v35
    v_mfma_f32_16x16x32_bf16 v[100:103], a[48:51], a[0:3], v[100:103]
    buffer_load_dwordx4 a[240:243], v28, s[20:23], s31 offen offset:1024 sc1
    v_and_b32 v83, s36, v39
    v_mfma_f32_16x16x32_bf16 v[104:107], a[52:55], a[0:3], v[104:107]
    v_cvt_pk_bf16_f32 v54, v48, v50
    v_sub_f32 v80, v80, v81
    v_mfma_f32_16x16x32_bf16 v[108:111], a[44:47], a[4:7], v[108:111]
    ds_read_b128 a[0:3], v10 offset:20992
    v_sub_f32 v82, v82, v83
    v_mfma_f32_16x16x32_bf16 v[112:115], a[48:51], a[4:7], v[112:115]
    buffer_load_dwordx4 a[244:247], v28, s[20:23], s31 offen offset:2048 sc1
    v_cvt_pk_bf16_f32 v55, v80, v82
    v_mfma_f32_16x16x32_bf16 v[116:119], a[52:55], a[4:7], v[116:119]
    ds_write_b64 v18, v[52:53] offset:32768
    v_mfma_f32_16x16x32_bf16 v[120:123], a[44:47], a[8:11], v[120:123]
    ds_read_b128 a[4:7], v10 offset:23296
    v_mfma_f32_16x16x32_bf16 v[124:127], a[48:51], a[8:11], v[124:127]
    ds_write_b64 v18, v[54:55] offset:32776
    ds_read_b128 v[32:35], v20 offset:20736
    v_mfma_f32_16x16x32_bf16 v[128:131], a[52:55], a[8:11], v[128:131]
    ds_read_b128 v[36:39], v20 offset:18432
    s_waitcnt lgkmcnt(8)
    v_mfma_f32_16x16x32_bf16 v[132:135], a[44:47], a[12:15], v[132:135]
    ds_read_b128 a[8:11], v10 offset:25600
    v_lshlrev_b32 v48, 16, v40
    v_mfma_f32_16x16x32_bf16 v[136:139], a[48:51], a[12:15], v[136:139]
    v_lshlrev_b32 v49, 16, v44
    v_and_b32 v50, s36, v40
    v_and_b32 v51, s36, v44
    v_mfma_f32_16x16x32_bf16 v[140:143], a[52:55], a[12:15], v[140:143]
    v_lshlrev_b32 v80, 16, v41
    v_lshlrev_b32 v81, 16, v45
    v_mfma_f32_16x16x32_bf16 v[144:147], a[44:47], a[16:19], v[144:147]
    ds_read_b128 a[12:15], v10 offset:27904
    v_sub_f32 v48, v48, v49
    v_mfma_f32_16x16x32_bf16 v[148:151], a[48:51], a[16:19], v[148:151]
    v_sub_f32 v50, v50, v51
    v_and_b32 v82, s36, v41
    v_and_b32 v83, s36, v45
    v_mfma_f32_16x16x32_bf16 v[152:155], a[52:55], a[16:19], v[152:155]
    v_cvt_pk_bf16_f32 v56, v48, v50
    v_sub_f32 v80, v80, v81
    v_mfma_f32_16x16x32_bf16 v[156:159], a[44:47], a[20:23], v[156:159]
    ds_read_b128 a[16:19], v10 offset:30208
    v_lshlrev_b32 v48, 16, v42
    v_mfma_f32_16x16x32_bf16 v[160:163], a[48:51], a[20:23], v[160:163]
    v_sub_f32 v82, v82, v83
    v_lshlrev_b32 v49, 16, v46
    v_mfma_f32_16x16x32_bf16 v[164:167], a[52:55], a[20:23], v[164:167]
    s_nop 3
    v_add_f32 v252, v84, v168
    v_add_f32 v253, v85, v169
    v_add_f32 v254, v86, v170
    v_add_f32 v255, v87, v171
    v_sub_f32 v168, v84, v168
    v_sub_f32 v169, v85, v169
    v_sub_f32 v170, v86, v170
    v_sub_f32 v171, v87, v171
    v_add_f32 v84, v88, v172
    v_add_f32 v85, v89, v173
    v_add_f32 v86, v90, v174
    v_add_f32 v87, v91, v175
    v_sub_f32 v172, v88, v172
    v_sub_f32 v173, v89, v173
    v_sub_f32 v174, v90, v174
    v_sub_f32 v175, v91, v175
    v_add_f32 v88, v92, v176
    v_add_f32 v89, v93, v177
    v_add_f32 v90, v94, v178
    v_add_f32 v91, v95, v179
    v_sub_f32 v176, v92, v176
    v_sub_f32 v177, v93, v177
    v_sub_f32 v178, v94, v178
    v_sub_f32 v179, v95, v179
    v_add_f32 v92, v96, v180
    v_add_f32 v93, v97, v181
    v_add_f32 v94, v98, v182
    v_add_f32 v95, v99, v183
    v_sub_f32 v180, v96, v180
    v_sub_f32 v181, v97, v181
    v_sub_f32 v182, v98, v182
    v_sub_f32 v183, v99, v183
    v_add_f32 v96, v100, v184
    v_add_f32 v97, v101, v185
    v_add_f32 v98, v102, v186
    v_add_f32 v99, v103, v187
    v_sub_f32 v184, v100, v184
    v_sub_f32 v185, v101, v185
    v_sub_f32 v186, v102, v186
    v_sub_f32 v187, v103, v187
    v_add_f32 v100, v104, v188
    v_add_f32 v101, v105, v189
    v_add_f32 v102, v106, v190
    v_add_f32 v103, v107, v191
    v_sub_f32 v188, v104, v188
    v_sub_f32 v189, v105, v189
    v_sub_f32 v190, v106, v190
    v_sub_f32 v191, v107, v191
    v_add_f32 v104, v108, v192
    v_add_f32 v105, v109, v193
    v_add_f32 v106, v110, v194
    v_add_f32 v107, v111, v195
    v_sub_f32 v192, v108, v192
    v_sub_f32 v193, v109, v193
    v_sub_f32 v194, v110, v194
    v_sub_f32 v195, v111, v195
    v_add_f32 v108, v112, v196
    v_add_f32 v109, v113, v197
    v_add_f32 v110, v114, v198
    v_add_f32 v111, v115, v199
    v_sub_f32 v196, v112, v196
    v_sub_f32 v197, v113, v197
    v_sub_f32 v198, v114, v198
    v_sub_f32 v199, v115, v199
    v_add_f32 v112, v116, v200
    v_add_f32 v113, v117, v201
    v_add_f32 v114, v118, v202
    v_add_f32 v115, v119, v203
    v_sub_f32 v200, v116, v200
    v_sub_f32 v201, v117, v201
    v_sub_f32 v202, v118, v202
    v_sub_f32 v203, v119, v203
    v_add_f32 v116, v120, v204
    v_add_f32 v117, v121, v205
    v_add_f32 v118, v122, v206
    v_add_f32 v119, v123, v207
    v_sub_f32 v204, v120, v204
    v_sub_f32 v205, v121, v205
    v_sub_f32 v206, v122, v206
    v_sub_f32 v207, v123, v207
    v_add_f32 v120, v124, v208
    v_add_f32 v121, v125, v209
    v_add_f32 v122, v126, v210
L_pad4:
    s_cbranch_vccnz L_pad5
    v_add_f32 v123, v127, v211
    v_sub_f32 v208, v124, v208
    v_sub_f32 v209, v125, v209
    v_sub_f32 v210, v126, v210
    v_sub_f32 v211, v127, v211
    v_add_f32 v124, v128, v212
    v_add_f32 v125, v129, v213
    v_add_f32 v126, v130, v214
    v_add_f32 v127, v131, v215
    v_sub_f32 v212, v128, v212
    v_sub_f32 v213, v129, v213
    v_sub_f32 v214, v130, v214
    v_sub_f32 v215, v131, v215
    v_add_f32 v128, v132, v216
    v_add_f32 v129, v133, v217
    v_add_f32 v130, v134, v218
    v_add_f32 v131, v135, v219
    v_sub_f32 v216, v132, v216
    v_sub_f32 v217, v133, v217
    v_sub_f32 v218, v134, v218
    v_sub_f32 v219, v135, v219
    v_add_f32 v132, v136, v220
    v_add_f32 v133, v137, v221
    v_add_f32 v134, v138, v222
    v_add_f32 v135, v139, v223
    v_sub_f32 v220, v136, v220
    v_sub_f32 v221, v137, v221
    v_sub_f32 v222, v138, v222
    v_sub_f32 v223, v139, v223
    v_add_f32 v136, v140, v224
    v_add_f32 v137, v141, v225
    v_add_f32 v138, v142, v226
    v_add_f32 v139, v143, v227
    v_sub_f32 v224, v140, v224
    v_sub_f32 v225, v141, v225
    v_sub_f32 v226, v142, v226
    v_sub_f32 v227, v143, v227
    v_add_f32 v140, v144, v228
    v_add_f32 v141, v145, v229
    v_add_f32 v142, v146, v230
    v_add_f32 v143, v147, v231
    v_sub_f32 v228, v144, v228
    v_sub_f32 v229, v145, v229
    v_sub_f32 v230, v146, v230
    v_sub_f32 v231, v147, v231
    v_add_f32 v144, v148, v232
    v_add_f32 v145, v149, v233
    v_add_f32 v146, v150, v234
    v_add_f32 v147, v151, v235
    v_sub_f32 v232, v148, v232
    v_sub_f32 v233, v149, v233
    v_sub_f32 v234, v150, v234
    v_sub_f32 v235, v151, v235
    v_add_f32 v148, v152, v236
    v_add_f32 v149, v153, v237
    v_add_f32 v150, v154, v238
    v_add_f32 v151, v155, v239
    v_sub_f32 v236, v152, v236
    v_sub_f32 v237, v153, v237
    v_sub_f32 v238, v154, v238
    v_sub_f32 v239, v155, v239
    v_add_f32 v152, v156, v240
    v_add_f32 v153, v157, v241
    v_add_f32 v154, v158, v242
    v_add_f32 v155, v159, v243
    v_sub_f32 v240, v156, v240
    v_sub_f32 v241, v157, v241
    v_sub_f32 v242, v158, v242
    v_sub_f32 v243, v159, v243
    v_add_f32 v156, v160, v244
    v_add_f32 v157, v161, v245
    v_add_f32 v158, v162, v246
    v_add_f32 v159, v163, v247
    v_sub_f32 v244, v160, v244
    v_sub_f32 v245, v161, v245
    v_sub_f32 v246, v162, v246
    v_sub_f32 v247, v163, v247
    v_add_f32 v160, v164, v248
    v_add_f32 v161, v165, v249
    v_add_f32 v162, v166, v250
    v_add_f32 v163, v167, v251
    v_sub_f32 v248, v164, v248
    v_sub_f32 v249, v165, v249
    v_sub_f32 v250, v166, v250
    v_sub_f32 v251, v167, v251
    s_nop 1
    s_waitcnt vmcnt(18)
    s_waitcnt lgkmcnt(8)
    v_mfma_f32_16x16x32_bf16 v[252:255], a[80:83], a[24:27], v[252:255]
    ds_read_b128 a[20:23], v11 offset:16384
    s_mov_b32 s31, 503808
    v_mfma_f32_16x16x32_bf16 v[84:87], a[84:87], a[24:27], v[84:87]
    buffer_load_dwordx4 a[44:47], v28, s[20:23], s31 offen offset:0 sc1
    v_mfma_f32_16x16x32_bf16 v[88:91], a[88:91], a[24:27], v[88:91]
    v_and_b32 v50, s36, v42
    v_and_b32 v51, s36, v46
    v_mfma_f32_16x16x32_bf16 v[92:95], a[80:83], a[28:31], v[92:95]
    ds_read_b128 a[24:27], v11 offset:18688
    v_cvt_pk_bf16_f32 v57, v80, v82
    v_mfma_f32_16x16x32_bf16 v[96:99], a[84:87], a[28:31], v[96:99]
    buffer_load_dwordx4 a[48:51], v28, s[20:23], s31 offen offset:1024 sc1
    v_mfma_f32_16x16x32_bf16 v[100:103], a[88:91], a[28:31], v[100:103]
    v_lshlrev_b32 v80, 16, v43
    v_sub_f32 v48, v48, v49
    v_mfma_f32_16x16x32_bf16 v[104:107], a[80:83], a[0:3], v[104:107]
    ds_read_b128 a[28:31], v11 offset:20992
    v_lshlrev_b32 v81, 16, v47
    v_mfma_f32_16x16x32_bf16 v[108:111], a[84:87], a[0:3], v[108:111]
    buffer_load_dwordx4 a[52:55], v28, s[20:23], s31 offen offset:2048 sc1
    v_mfma_f32_16x16x32_bf16 v[112:115], a[88:91], a[0:3], v[112:115]
    v_sub_f32 v50, v50, v51
    s_waitcnt lgkmcnt(4)
    v_mfma_f32_16x16x32_bf16 v[116:119], a[80:83], a[4:7], v[116:119]
    ds_read_b128 a[0:3], v11 offset:23296
    v_and_b32 v82, s36, v43
    v_mfma_f32_16x16x32_bf16 v[120:123], a[84:87], a[4:7], v[120:123]
    v_and_b32 v83, s36, v47
    v_cvt_pk_bf16_f32 v58, v48, v50
    v_mfma_f32_16x16x32_bf16 v[124:127], a[88:91], a[4:7], v[124:127]
    v_sub_f32 v80, v80, v81
    v_sub_f32 v82, v82, v83
    v_mfma_f32_16x16x32_bf16 v[128:131], a[80:83], a[8:11], v[128:131]
    ds_read_b128 a[4:7], v11 offset:25600
    v_cvt_pk_bf16_f32 v59, v80, v82
    v_mfma_f32_16x16x32_bf16 v[132:135], a[84:87], a[8:11], v[132:135]
    ds_write_b64 v19, v[56:57] offset:32768
    v_mfma_f32_16x16x32_bf16 v[136:139], a[88:91], a[8:11], v[136:139]
    ds_write_b64 v19, v[58:59] offset:32776
    v_mfma_f32_16x16x32_bf16 v[140:143], a[80:83], a[12:15], v[140:143]
    ds_read_b128 a[8:11], v11 offset:27904
    ds_read_b128 v[40:43], v21 offset:20736
    v_mfma_f32_16x16x32_bf16 v[144:147], a[84:87], a[12:15], v[144:147]
    ds_read_b128 v[44:47], v21 offset:18432
    v_lshlrev_b32 v48, 16, v32
    v_lshlrev_b32 v49, 16, v36
    v_mfma_f32_16x16x32_bf16 v[148:151], a[88:91], a[12:15], v[148:151]
    v_and_b32 v50, s36, v32
    s_waitcnt lgkmcnt(8)
    v_mfma_f32_16x16x32_bf16 v[152:155], a[80:83], a[16:19], v[152:155]
    ds_read_b128 a[12:15], v11 offset:30208
    v_and_b32 v51, s36, v36
    v_mfma_f32_16x16x32_bf16 v[156:159], a[84:87], a[16:19], v[156:159]
    v_lshlrev_b32 v80, 16, v33
    v_lshlrev_b32 v81, 16, v37
    v_sub_f32 v48, v48, v49
    v_mfma_f32_16x16x32_bf16 v[160:163], a[88:91], a[16:19], v[160:163]
    v_sub_f32 v50, v50, v51
    s_waitcnt vmcnt(18)
    v_mfma_f32_16x16x32_bf16 v[252:255], a[92:95], a[20:23], v[252:255]
    ds_read_b128 a[16:19], v12 offset:16384
    s_mov_b32 s31, 516096
    v_mfma_f32_16x16x32_bf16 v[84:87], a[96:99], a[20:23], v[84:87]
    buffer_load_dwordx4 a[80:83], v28, s[20:23], s31 offen offset:0 sc1
    v_and_b32 v82, s36, v33
    v_mfma_f32_16x16x32_bf16 v[88:91], a[100:103], a[20:23], v[88:91]
    v_and_b32 v83, s36, v37
    v_cvt_pk_bf16_f32 v52, v48, v50
    v_mfma_f32_16x16x32_bf16 v[92:95], a[92:95], a[24:27], v[92:95]
    ds_read_b128 a[20:23], v12 offset:18688
    v_sub_f32 v80, v80, v81
    v_mfma_f32_16x16x32_bf16 v[96:99], a[96:99], a[24:27], v[96:99]
    buffer_load_dwordx4 a[84:87], v28, s[20:23], s31 offen offset:1024 sc1
    v_lshlrev_b32 v48, 16, v34
    v_mfma_f32_16x16x32_bf16 v[100:103], a[100:103], a[24:27], v[100:103]
    v_sub_f32 v82, v82, v83
    s_waitcnt lgkmcnt(8)
    v_mfma_f32_16x16x32_bf16 v[104:107], a[92:95], a[28:31], v[104:107]
    ds_read_b128 a[24:27], v12 offset:20992
    v_lshlrev_b32 v49, 16, v38
    v_mfma_f32_16x16x32_bf16 v[108:111], a[96:99], a[28:31], v[108:111]
    buffer_load_dwordx4 a[88:91], v28, s[20:23], s31 offen offset:2048 sc1
    v_and_b32 v50, s36, v34
    v_mfma_f32_16x16x32_bf16 v[112:115], a[100:103], a[28:31], v[112:115]
    v_and_b32 v51, s36, v38
    v_cvt_pk_bf16_f32 v53, v80, v82
    s_waitcnt lgkmcnt(7)
    s_barrier
    v_mfma_f32_16x16x32_bf16 v[116:119], a[92:95], a[0:3], v[116:119]
    ds_read_b128 a[28:31], v12 offset:23296
    v_lshlrev_b32 v80, 16, v35
    v_mfma_f32_16x16x32_bf16 v[120:123], a[96:99], a[0:3], v[120:123]
    v_sub_f32 v48, v48, v49
    v_lshlrev_b32 v81, 16, v39
    v_sub_f32 v50, v50, v51
    v_mfma_f32_16x16x32_bf16 v[124:127], a[100:103], a[0:3], v[124:127]
    v_and_b32 v82, s36, v35
    v_and_b32 v83, s36, v39
    v_mfma_f32_16x16x32_bf16 v[128:131], a[92:95], a[4:7], v[128:131]
    ds_read_b128 a[0:3], v12 offset:25600
    v_cvt_pk_bf16_f32 v54, v48, v50
    v_mfma_f32_16x16x32_bf16 v[132:135], a[96:99], a[4:7], v[132:135]
    v_sub_f32 v80, v80, v81
    v_sub_f32 v82, v82, v83
    v_cvt_pk_bf16_f32 v55, v80, v82
    v_mfma_f32_16x16x32_bf16 v[136:139], a[100:103], a[4:7], v[136:139]
    s_waitcnt lgkmcnt(4)
    v_mfma_f32_16x16x32_bf16 v[140:143], a[92:95], a[8:11], v[140:143]
    ds_read_b128 a[4:7], v12 offset:27904
    v_mfma_f32_16x16x32_bf16 v[144:147], a[96:99], a[8:11], v[144:147]
    ds_write_b64 v16, v[52:53] offset:0
    v_mfma_f32_16x16x32_bf16 v[148:151], a[100:103], a[8:11], v[148:151]
    ds_write_b64 v16, v[54:55] offset:8
    v_mfma_f32_16x16x32_bf16 v[152:155], a[92:95], a[12:15], v[152:155]
    ds_read_b128 a[8:11], v12 offset:30208
    ds_read_b128 v[32:35], v22 offset:20736
    v_mfma_f32_16x16x32_bf16 v[156:159], a[96:99], a[12:15], v[156:159]
    ds_read_b128 v[36:39], v22 offset:18432
    v_lshlrev_b32 v48, 16, v40
    v_lshlrev_b32 v49, 16, v44
    v_mfma_f32_16x16x32_bf16 v[160:163], a[100:103], a[12:15], v[160:163]
    v_and_b32 v50, s36, v40
    s_waitcnt vmcnt(15)
    v_mfma_f32_16x16x32_bf16 v[252:255], a[152:155], a[16:19], v[252:255]
    ds_read_b128 a[12:15], v13 offset:16384
    s_mov_b32 s31, 528384
    v_mfma_f32_16x16x32_bf16 v[84:87], a[156:159], a[16:19], v[84:87]
    buffer_load_dwordx4 a[92:95], v28, s[20:23], s31 offen offset:0 sc1
    v_and_b32 v51, s36, v44
    v_mfma_f32_16x16x32_bf16 v[88:91], a[160:163], a[16:19], v[88:91]
    v_lshlrev_b32 v80, 16, v41
    s_waitcnt lgkmcnt(8)
    v_mfma_f32_16x16x32_bf16 v[92:95], a[152:155], a[20:23], v[92:95]
    ds_read_b128 a[16:19], v13 offset:18688
    v_lshlrev_b32 v81, 16, v45
    v_mfma_f32_16x16x32_bf16 v[96:99], a[156:159], a[20:23], v[96:99]
    buffer_load_dwordx4 a[96:99], v28, s[20:23], s31 offen offset:1024 sc1
    v_sub_f32 v48, v48, v49
    v_mfma_f32_16x16x32_bf16 v[100:103], a[160:163], a[20:23], v[100:103]
    v_sub_f32 v50, v50, v51
    v_and_b32 v82, s36, v41
    v_mfma_f32_16x16x32_bf16 v[104:107], a[152:155], a[24:27], v[104:107]
    ds_read_b128 a[20:23], v13 offset:20992
    v_and_b32 v83, s36, v45
    v_mfma_f32_16x16x32_bf16 v[108:111], a[156:159], a[24:27], v[108:111]
    buffer_load_dwordx4 a[100:103], v28, s[20:23], s31 offen offset:2048 sc1
    v_cvt_pk_bf16_f32 v56, v48, v50
    v_mfma_f32_16x16x32_bf16 v[112:115], a[160:163], a[24:27], v[112:115]
    v_sub_f32 v80, v80, v81
    v_lshlrev_b32 v48, 16, v42
    v_mfma_f32_16x16x32_bf16 v[116:119], a[152:155], a[28:31], v[116:119]
    ds_read_b128 a[24:27], v13 offset:23296
    v_sub_f32 v82, v82, v83
    v_mfma_f32_16x16x32_bf16 v[120:123], a[156:159], a[28:31], v[120:123]
    v_lshlrev_b32 v49, 16, v46
    v_and_b32 v50, s36, v42
    v_and_b32 v51, s36, v46
    v_mfma_f32_16x16x32_bf16 v[124:127], a[160:163], a[28:31], v[124:127]
    v_cvt_pk_bf16_f32 v57, v80, v82
    s_waitcnt lgkmcnt(6)
    v_mfma_f32_16x16x32_bf16 v[128:131], a[152:155], a[0:3], v[128:131]
    ds_read_b128 a[28:31], v13 offset:25600
    v_lshlrev_b32 v80, 16, v43
    v_mfma_f32_16x16x32_bf16 v[132:135], a[156:159], a[0:3], v[132:135]
    v_sub_f32 v48, v48, v49
    v_lshlrev_b32 v81, 16, v47
    v_sub_f32 v50, v50, v51
    v_mfma_f32_16x16x32_bf16 v[136:139], a[160:163], a[0:3], v[136:139]
    v_and_b32 v82, s36, v43
    v_and_b32 v83, s36, v47
    v_mfma_f32_16x16x32_bf16 v[140:143], a[152:155], a[4:7], v[140:143]
    ds_read_b128 a[0:3], v13 offset:27904
    v_cvt_pk_bf16_f32 v58, v48, v50
    v_mfma_f32_16x16x32_bf16 v[144:147], a[156:159], a[4:7], v[144:147]
    v_sub_f32 v80, v80, v81
    v_sub_f32 v82, v82, v83
    v_cvt_pk_bf16_f32 v59, v80, v82
    v_mfma_f32_16x16x32_bf16 v[148:151], a[160:163], a[4:7], v[148:151]
    ds_write_b64 v17, v[56:57] offset:0
    v_mfma_f32_16x16x32_bf16 v[152:155], a[152:155], a[8:11], v[152:155]
    ds_read_b128 a[4:7], v13 offset:30208
    v_mfma_f32_16x16x32_bf16 v[156:159], a[156:159], a[8:11], v[156:159]
    ds_write_b64 v17, v[58:59] offset:8
    ds_read_b128 v[40:43], v23 offset:20736
    v_mfma_f32_16x16x32_bf16 v[160:163], a[160:163], a[8:11], v[160:163]
    s_waitcnt vmcnt(15)
    s_waitcnt lgkmcnt(7)
    v_mfma_f32_16x16x32_bf16 v[252:255], a[188:191], a[12:15], v[252:255]
    ds_read_b128 a[8:11], v14 offset:16384
    s_mov_b32 s31, 540672
    v_mfma_f32_16x16x32_bf16 v[84:87], a[192:195], a[12:15], v[84:87]
    buffer_load_dwordx4 a[152:155], v28, s[20:23], s31 offen offset:0 sc1
    ds_read_b128 v[44:47], v23 offset:18432
    v_mfma_f32_16x16x32_bf16 v[88:91], a[196:199], a[12:15], v[88:91]
    v_lshlrev_b32 v48, 16, v32
    v_lshlrev_b32 v49, 16, v36
    v_mfma_f32_16x16x32_bf16 v[92:95], a[188:191], a[16:19], v[92:95]
    ds_read_b128 a[12:15], v14 offset:18688
    v_and_b32 v50, s36, v32
    v_mfma_f32_16x16x32_bf16 v[96:99], a[192:195], a[16:19], v[96:99]
    buffer_load_dwordx4 a[156:159], v28, s[20:23], s31 offen offset:1024 sc1
    v_mfma_f32_16x16x32_bf16 v[100:103], a[196:199], a[16:19], v[100:103]
    v_and_b32 v51, s36, v36
    v_lshlrev_b32 v80, 16, v33
    v_mfma_f32_16x16x32_bf16 v[104:107], a[188:191], a[20:23], v[104:107]
    ds_read_b128 a[16:19], v14 offset:20992
    v_lshlrev_b32 v81, 16, v37
    v_mfma_f32_16x16x32_bf16 v[108:111], a[192:195], a[20:23], v[108:111]
    buffer_load_dwordx4 a[160:163], v28, s[20:23], s31 offen offset:2048 sc1
    v_mfma_f32_16x16x32_bf16 v[112:115], a[196:199], a[20:23], v[112:115]
    v_sub_f32 v48, v48, v49
    s_waitcnt lgkmcnt(8)
    v_mfma_f32_16x16x32_bf16 v[116:119], a[188:191], a[24:27], v[116:119]
    ds_read_b128 a[20:23], v14 offset:23296
    v_sub_f32 v50, v50, v51
    v_mfma_f32_16x16x32_bf16 v[120:123], a[192:195], a[24:27], v[120:123]
    v_and_b32 v82, s36, v33
    v_and_b32 v83, s36, v37
    v_cvt_pk_bf16_f32 v52, v48, v50
    v_mfma_f32_16x16x32_bf16 v[124:127], a[196:199], a[24:27], v[124:127]
    v_sub_f32 v80, v80, v81
    v_lshlrev_b32 v48, 16, v34
    v_mfma_f32_16x16x32_bf16 v[128:131], a[188:191], a[28:31], v[128:131]
    ds_read_b128 a[24:27], v14 offset:25600
    v_sub_f32 v82, v82, v83
    v_mfma_f32_16x16x32_bf16 v[132:135], a[192:195], a[28:31], v[132:135]
    v_lshlrev_b32 v49, 16, v38
    v_and_b32 v50, s36, v34
    v_mfma_f32_16x16x32_bf16 v[136:139], a[196:199], a[28:31], v[136:139]
    v_and_b32 v51, s36, v38
    v_cvt_pk_bf16_f32 v53, v80, v82
    v_mfma_f32_16x16x32_bf16 v[140:143], a[188:191], a[0:3], v[140:143]
    ds_read_b128 a[28:31], v14 offset:27904
    v_lshlrev_b32 v80, 16, v35
    v_mfma_f32_16x16x32_bf16 v[144:147], a[192:195], a[0:3], v[144:147]
    v_sub_f32 v48, v48, v49
    v_lshlrev_b32 v81, 16, v39
    v_mfma_f32_16x16x32_bf16 v[148:151], a[196:199], a[0:3], v[148:151]
    v_sub_f32 v50, v50, v51
    s_waitcnt lgkmcnt(4)
    v_mfma_f32_16x16x32_bf16 v[152:155], a[188:191], a[4:7], v[152:155]
    ds_read_b128 a[0:3], v14 offset:30208
    v_and_b32 v82, s36, v35
    v_mfma_f32_16x16x32_bf16 v[156:159], a[192:195], a[4:7], v[156:159]
    v_and_b32 v83, s36, v39
    v_cvt_pk_bf16_f32 v54, v48, v50
    v_mfma_f32_16x16x32_bf16 v[160:163], a[196:199], a[4:7], v[160:163]
    v_sub_f32 v80, v80, v81
    s_waitcnt vmcnt(12)
    v_mfma_f32_16x16x32_bf16 v[252:255], a[236:239], a[8:11], v[252:255]
    ds_read_b128 a[4:7], v15 offset:16384
    s_mov_b32 s31, 552960
    v_mfma_f32_16x16x32_bf16 v[84:87], a[240:243], a[8:11], v[84:87]
    buffer_load_dwordx4 a[188:191], v28, s[20:23], s31 offen offset:0 sc1
    v_mfma_f32_16x16x32_bf16 v[88:91], a[244:247], a[8:11], v[88:91]
    v_sub_f32 v82, v82, v83
    v_cvt_pk_bf16_f32 v55, v80, v82
    v_mfma_f32_16x16x32_bf16 v[92:95], a[236:239], a[12:15], v[92:95]
    ds_read_b128 a[8:11], v15 offset:18688
    v_mfma_f32_16x16x32_bf16 v[96:99], a[240:243], a[12:15], v[96:99]
    buffer_load_dwordx4 a[192:195], v28, s[20:23], s31 offen offset:1024 sc1
    v_mfma_f32_16x16x32_bf16 v[100:103], a[244:247], a[12:15], v[100:103]
    s_waitcnt lgkmcnt(4)
    v_mfma_f32_16x16x32_bf16 v[104:107], a[236:239], a[16:19], v[104:107]
    ds_read_b128 a[12:15], v15 offset:20992
    v_mfma_f32_16x16x32_bf16 v[108:111], a[240:243], a[16:19], v[108:111]
    buffer_load_dwordx4 a[196:199], v28, s[20:23], s31 offen offset:2048 sc1
    v_mfma_f32_16x16x32_bf16 v[112:115], a[244:247], a[16:19], v[112:115]
    ds_write_b64 v18, v[52:53] offset:0
    v_mfma_f32_16x16x32_bf16 v[116:119], a[236:239], a[20:23], v[116:119]
    ds_read_b128 a[16:19], v15 offset:23296
    v_mfma_f32_16x16x32_bf16 v[120:123], a[240:243], a[20:23], v[120:123]
    ds_write_b64 v18, v[54:55] offset:8
    v_mfma_f32_16x16x32_bf16 v[124:127], a[244:247], a[20:23], v[124:127]
    ds_read_b128 v[32:35], v20 offset:57600
    ds_read_b128 v[36:39], v20 offset:55296
    v_mfma_f32_16x16x32_bf16 v[128:131], a[236:239], a[24:27], v[128:131]
    ds_read_b128 a[20:23], v15 offset:25600
    v_lshlrev_b32 v48, 16, v40
    v_mfma_f32_16x16x32_bf16 v[132:135], a[240:243], a[24:27], v[132:135]
    v_lshlrev_b32 v49, 16, v44
    v_and_b32 v50, s36, v40
    v_mfma_f32_16x16x32_bf16 v[136:139], a[244:247], a[24:27], v[136:139]
    v_and_b32 v51, s36, v44
    s_waitcnt lgkmcnt(8)
    v_mfma_f32_16x16x32_bf16 v[140:143], a[236:239], a[28:31], v[140:143]
    ds_read_b128 a[24:27], v15 offset:27904
    v_lshlrev_b32 v80, 16, v41
    v_mfma_f32_16x16x32_bf16 v[144:147], a[240:243], a[28:31], v[144:147]
    v_lshlrev_b32 v81, 16, v45
    v_sub_f32 v48, v48, v49
    v_mfma_f32_16x16x32_bf16 v[148:151], a[244:247], a[28:31], v[148:151]
    v_sub_f32 v50, v50, v51
    v_and_b32 v82, s36, v41
    v_mfma_f32_16x16x32_bf16 v[152:155], a[236:239], a[0:3], v[152:155]
    ds_read_b128 a[28:31], v15 offset:30208
    v_and_b32 v83, s36, v45
    v_mfma_f32_16x16x32_bf16 v[156:159], a[240:243], a[0:3], v[156:159]
    v_cvt_pk_bf16_f32 v56, v48, v50
    v_sub_f32 v80, v80, v81
    v_mfma_f32_16x16x32_bf16 v[160:163], a[244:247], a[0:3], v[160:163]
    v_lshlrev_b32 v48, 16, v42
    s_waitcnt vmcnt(12)
    v_mfma_f32_16x16x32_bf16 v[252:255], a[44:47], a[4:7], v[252:255]
    ds_read_b128 a[0:3], v10 offset:32768
    s_mov_b32 s31, 565248
    v_mfma_f32_16x16x32_bf16 v[84:87], a[48:51], a[4:7], v[84:87]
    buffer_load_dwordx4 a[236:239], v28, s[20:23], s31 offen offset:0 sc1
    v_mfma_f32_16x16x32_bf16 v[88:91], a[52:55], a[4:7], v[88:91]
    v_sub_f32 v82, v82, v83
    s_waitcnt lgkmcnt(7)
    v_mfma_f32_16x16x32_bf16 v[92:95], a[44:47], a[8:11], v[92:95]
    ds_read_b128 a[4:7], v10 offset:35072
    v_lshlrev_b32 v49, 16, v46
    v_mfma_f32_16x16x32_bf16 v[96:99], a[48:51], a[8:11], v[96:99]
    buffer_load_dwordx4 a[240:243], v28, s[20:23], s31 offen offset:1024 sc1
    v_mfma_f32_16x16x32_bf16 v[100:103], a[52:55], a[8:11], v[100:103]
    v_and_b32 v50, s36, v42
    v_and_b32 v51, s36, v46
    v_mfma_f32_16x16x32_bf16 v[104:107], a[44:47], a[12:15], v[104:107]
    ds_read_b128 a[8:11], v10 offset:37376
    v_cvt_pk_bf16_f32 v57, v80, v82
    v_mfma_f32_16x16x32_bf16 v[108:111], a[48:51], a[12:15], v[108:111]
    buffer_load_dwordx4 a[244:247], v28, s[20:23], s31 offen offset:2048 sc1
    v_mfma_f32_16x16x32_bf16 v[112:115], a[52:55], a[12:15], v[112:115]
    v_lshlrev_b32 v80, 16, v43
    v_sub_f32 v48, v48, v49
    v_mfma_f32_16x16x32_bf16 v[116:119], a[44:47], a[16:19], v[116:119]
    ds_read_b128 a[12:15], v10 offset:39680
    v_lshlrev_b32 v81, 16, v47
    v_mfma_f32_16x16x32_bf16 v[120:123], a[48:51], a[16:19], v[120:123]
    v_sub_f32 v50, v50, v51
    v_and_b32 v82, s36, v43
    v_mfma_f32_16x16x32_bf16 v[124:127], a[52:55], a[16:19], v[124:127]
    v_and_b32 v83, s36, v47
    s_waitcnt lgkmcnt(4)
    v_mfma_f32_16x16x32_bf16 v[128:131], a[44:47], a[20:23], v[128:131]
    ds_read_b128 a[16:19], v10 offset:41984
    v_cvt_pk_bf16_f32 v58, v48, v50
    v_mfma_f32_16x16x32_bf16 v[132:135], a[48:51], a[20:23], v[132:135]
    v_sub_f32 v80, v80, v81
    v_sub_f32 v82, v82, v83
    v_mfma_f32_16x16x32_bf16 v[136:139], a[52:55], a[20:23], v[136:139]
    v_cvt_pk_bf16_f32 v59, v80, v82
    v_mfma_f32_16x16x32_bf16 v[140:143], a[44:47], a[24:27], v[140:143]
    ds_read_b128 a[20:23], v10 offset:44288
    v_mfma_f32_16x16x32_bf16 v[144:147], a[48:51], a[24:27], v[144:147]
    ds_write_b64 v19, v[56:57] offset:0
    v_mfma_f32_16x16x32_bf16 v[148:151], a[52:55], a[24:27], v[148:151]
    ds_write_b64 v19, v[58:59] offset:8
    v_mfma_f32_16x16x32_bf16 v[152:155], a[44:47], a[28:31], v[152:155]
    ds_read_b128 a[24:27], v10 offset:46592
    ds_read_b128 v[40:43], v21 offset:57600
    v_mfma_f32_16x16x32_bf16 v[156:159], a[48:51], a[28:31], v[156:159]
    ds_read_b128 v[44:47], v21 offset:55296
    v_lshlrev_b32 v48, 16, v32
    v_lshlrev_b32 v49, 16, v36
    v_mfma_f32_16x16x32_bf16 v[160:163], a[52:55], a[28:31], v[160:163]
    s_waitcnt vmcnt(12)
    s_waitcnt lgkmcnt(8)
    v_mfma_f32_16x16x32_bf16 v[252:255], a[80:83], a[0:3], v[252:255]
    ds_read_b128 a[28:31], v11 offset:32768
    s_mov_b32 s31, 577536
    v_mfma_f32_16x16x32_bf16 v[84:87], a[84:87], a[0:3], v[84:87]
    buffer_load_dwordx4 a[44:47], v28, s[20:23], s31 offen offset:0 sc1
    v_and_b32 v50, s36, v32
    v_mfma_f32_16x16x32_bf16 v[88:91], a[88:91], a[0:3], v[88:91]
    v_and_b32 v51, s36, v36
    v_lshlrev_b32 v80, 16, v33
    v_mfma_f32_16x16x32_bf16 v[92:95], a[80:83], a[4:7], v[92:95]
    ds_read_b128 a[0:3], v11 offset:35072
    v_lshlrev_b32 v81, 16, v37
    v_mfma_f32_16x16x32_bf16 v[96:99], a[84:87], a[4:7], v[96:99]
    buffer_load_dwordx4 a[48:51], v28, s[20:23], s31 offen offset:1024 sc1
    v_sub_f32 v48, v48, v49
    v_mfma_f32_16x16x32_bf16 v[100:103], a[88:91], a[4:7], v[100:103]
    v_sub_f32 v50, v50, v51
    v_and_b32 v82, s36, v33
    v_mfma_f32_16x16x32_bf16 v[104:107], a[80:83], a[8:11], v[104:107]
    ds_read_b128 a[4:7], v11 offset:37376
    v_and_b32 v83, s36, v37
    v_mfma_f32_16x16x32_bf16 v[108:111], a[84:87], a[8:11], v[108:111]
    buffer_load_dwordx4 a[52:55], v28, s[20:23], s31 offen offset:2048 sc1
    v_cvt_pk_bf16_f32 v52, v48, v50
    v_mfma_f32_16x16x32_bf16 v[112:115], a[88:91], a[8:11], v[112:115]
    v_sub_f32 v80, v80, v81
    s_waitcnt lgkmcnt(8)
    v_mfma_f32_16x16x32_bf16 v[116:119], a[80:83], a[12:15], v[116:119]
    ds_read_b128 a[8:11], v11 offset:39680
    v_lshlrev_b32 v48, 16, v34
    v_mfma_f32_16x16x32_bf16 v[120:123], a[84:87], a[12:15], v[120:123]
    v_sub_f32 v82, v82, v83
    v_lshlrev_b32 v49, 16, v38
    v_and_b32 v50, s36, v34
    v_mfma_f32_16x16x32_bf16 v[124:127], a[88:91], a[12:15], v[124:127]
    v_and_b32 v51, s36, v38
    v_cvt_pk_bf16_f32 v53, v80, v82
    v_mfma_f32_16x16x32_bf16 v[128:131], a[80:83], a[16:19], v[128:131]
    ds_read_b128 a[12:15], v11 offset:41984
    v_lshlrev_b32 v80, 16, v35
    v_mfma_f32_16x16x32_bf16 v[132:135], a[84:87], a[16:19], v[132:135]
    v_sub_f32 v48, v48, v49
    v_lshlrev_b32 v81, 16, v39
    v_sub_f32 v50, v50, v51
    v_mfma_f32_16x16x32_bf16 v[136:139], a[88:91], a[16:19], v[136:139]
    v_and_b32 v82, s36, v35
    v_and_b32 v83, s36, v39
    s_waitcnt lgkmcnt(8)
    s_barrier
    v_mfma_f32_16x16x32_bf16 v[140:143], a[80:83], a[20:23], v[140:143]
    ds_read_b128 a[16:19], v11 offset:44288
    v_cvt_pk_bf16_f32 v54, v48, v50
    v_mfma_f32_16x16x32_bf16 v[144:147], a[84:87], a[20:23], v[144:147]
    v_sub_f32 v80, v80, v81
    v_sub_f32 v82, v82, v83
    v_cvt_pk_bf16_f32 v55, v80, v82
    v_mfma_f32_16x16x32_bf16 v[148:151], a[88:91], a[20:23], v[148:151]
    s_waitcnt lgkmcnt(4)
    v_mfma_f32_16x16x32_bf16 v[152:155], a[80:83], a[24:27], v[152:155]
    ds_read_b128 a[20:23], v11 offset:46592
    v_mfma_f32_16x16x32_bf16 v[156:159], a[84:87], a[24:27], v[156:159]
    ds_write_b64 v16, v[52:53] offset:16384
    v_mfma_f32_16x16x32_bf16 v[160:163], a[88:91], a[24:27], v[160:163]
    s_waitcnt vmcnt(12)
    v_mfma_f32_16x16x32_bf16 v[252:255], a[92:95], a[28:31], v[252:255]
    ds_read_b128 a[24:27], v12 offset:32768
    s_mov_b32 s31, 589824
    v_mfma_f32_16x16x32_bf16 v[84:87], a[96:99], a[28:31], v[84:87]
    buffer_load_dwordx4 a[80:83], v28, s[20:23], s31 offen offset:0 sc1
    v_mfma_f32_16x16x32_bf16 v[88:91], a[100:103], a[28:31], v[88:91]
    ds_write_b64 v16, v[54:55] offset:16392
    v_mfma_f32_16x16x32_bf16 v[92:95], a[92:95], a[0:3], v[92:95]
    ds_read_b128 a[28:31], v12 offset:35072
    ds_read_b128 v[32:35], v22 offset:57600
    v_mfma_f32_16x16x32_bf16 v[96:99], a[96:99], a[0:3], v[96:99]
    buffer_load_dwordx4 a[84:87], v28, s[20:23], s31 offen offset:1024 sc1
    ds_read_b128 v[36:39], v22 offset:55296
    v_mfma_f32_16x16x32_bf16 v[100:103], a[100:103], a[0:3], v[100:103]
    v_lshlrev_b32 v48, 16, v40
    s_waitcnt lgkmcnt(8)
    v_mfma_f32_16x16x32_bf16 v[104:107], a[92:95], a[4:7], v[104:107]
    ds_read_b128 a[0:3], v12 offset:37376
    v_lshlrev_b32 v49, 16, v44
    v_mfma_f32_16x16x32_bf16 v[108:111], a[96:99], a[4:7], v[108:111]
    buffer_load_dwordx4 a[88:91], v28, s[20:23], s31 offen offset:2048 sc1
    v_and_b32 v50, s36, v40
    v_mfma_f32_16x16x32_bf16 v[112:115], a[100:103], a[4:7], v[112:115]
    v_and_b32 v51, s36, v44
    v_lshlrev_b32 v80, 16, v41
    v_mfma_f32_16x16x32_bf16 v[116:119], a[92:95], a[8:11], v[116:119]
    ds_read_b128 a[4:7], v12 offset:39680
    v_lshlrev_b32 v81, 16, v45
    v_mfma_f32_16x16x32_bf16 v[120:123], a[96:99], a[8:11], v[120:123]
    v_sub_f32 v48, v48, v49
    v_sub_f32 v50, v50, v51
    v_and_b32 v82, s36, v41
    v_mfma_f32_16x16x32_bf16 v[124:127], a[100:103], a[8:11], v[124:127]
    v_and_b32 v83, s36, v45
    v_cvt_pk_bf16_f32 v56, v48, v50
    v_mfma_f32_16x16x32_bf16 v[128:131], a[92:95], a[12:15], v[128:131]
    ds_read_b128 a[8:11], v12 offset:41984
    v_sub_f32 v80, v80, v81
    v_mfma_f32_16x16x32_bf16 v[132:135], a[96:99], a[12:15], v[132:135]
    v_lshlrev_b32 v48, 16, v42
    v_sub_f32 v82, v82, v83
    v_lshlrev_b32 v49, 16, v46
    v_mfma_f32_16x16x32_bf16 v[136:139], a[100:103], a[12:15], v[136:139]
    v_and_b32 v50, s36, v42
    s_waitcnt lgkmcnt(7)
    v_mfma_f32_16x16x32_bf16 v[140:143], a[92:95], a[16:19], v[140:143]
    ds_read_b128 a[12:15], v12 offset:44288
    v_and_b32 v51, s36, v46
    v_mfma_f32_16x16x32_bf16 v[144:147], a[96:99], a[16:19], v[144:147]
    v_cvt_pk_bf16_f32 v57, v80, v82
    v_lshlrev_b32 v80, 16, v43
    v_sub_f32 v48, v48, v49
    v_mfma_f32_16x16x32_bf16 v[148:151], a[100:103], a[16:19], v[148:151]
    v_lshlrev_b32 v81, 16, v47
    v_sub_f32 v50, v50, v51
    v_mfma_f32_16x16x32_bf16 v[152:155], a[92:95], a[20:23], v[152:155]
    ds_read_b128 a[16:19], v12 offset:46592
    v_and_b32 v82, s36, v43
    v_mfma_f32_16x16x32_bf16 v[156:159], a[96:99], a[20:23], v[156:159]
    v_and_b32 v83, s36, v47
    v_cvt_pk_bf16_f32 v58, v48, v50
    v_sub_f32 v80, v80, v81
    v_mfma_f32_16x16x32_bf16 v[160:163], a[100:103], a[20:23], v[160:163]
    v_sub_f32 v82, v82, v83
    s_waitcnt vmcnt(12)
    v_mfma_f32_16x16x32_bf16 v[252:255], a[152:155], a[24:27], v[252:255]
    ds_read_b128 a[20:23], v13 offset:32768
    s_mov_b32 s31, 602112
    v_mfma_f32_16x16x32_bf16 v[84:87], a[156:159], a[24:27], v[84:87]
    buffer_load_dwordx4 a[92:95], v28, s[20:23], s31 offen offset:0 sc1
    v_cvt_pk_bf16_f32 v59, v80, v82
    v_mfma_f32_16x16x32_bf16 v[88:91], a[160:163], a[24:27], v[88:91]
    s_waitcnt lgkmcnt(4)
    v_mfma_f32_16x16x32_bf16 v[92:95], a[152:155], a[28:31], v[92:95]
    ds_read_b128 a[24:27], v13 offset:35072
    v_mfma_f32_16x16x32_bf16 v[96:99], a[156:159], a[28:31], v[96:99]
    buffer_load_dwordx4 a[96:99], v28, s[20:23], s31 offen offset:1024 sc1
    v_mfma_f32_16x16x32_bf16 v[100:103], a[160:163], a[28:31], v[100:103]
    ds_write_b64 v17, v[56:57] offset:16384
    v_mfma_f32_16x16x32_bf16 v[104:107], a[152:155], a[0:3], v[104:107]
    ds_read_b128 a[28:31], v13 offset:37376
    v_mfma_f32_16x16x32_bf16 v[108:111], a[156:159], a[0:3], v[108:111]
    buffer_load_dwordx4 a[100:103], v28, s[20:23], s31 offen offset:2048 sc1
    v_mfma_f32_16x16x32_bf16 v[112:115], a[160:163], a[0:3], v[112:115]
    ds_write_b64 v17, v[58:59] offset:16392
    v_mfma_f32_16x16x32_bf16 v[116:119], a[152:155], a[4:7], v[116:119]
    ds_read_b128 a[0:3], v13 offset:39680
    ds_read_b128 v[40:43], v23 offset:57600
    v_mfma_f32_16x16x32_bf16 v[120:123], a[156:159], a[4:7], v[120:123]
    ds_read_b128 v[44:47], v23 offset:55296
    v_lshlrev_b32 v48, 16, v32
    v_lshlrev_b32 v49, 16, v36
    v_mfma_f32_16x16x32_bf16 v[124:127], a[160:163], a[4:7], v[124:127]
    v_and_b32 v50, s36, v32
    s_waitcnt lgkmcnt(8)
    v_mfma_f32_16x16x32_bf16 v[128:131], a[152:155], a[8:11], v[128:131]
    ds_read_b128 a[4:7], v13 offset:41984
    v_and_b32 v51, s36, v36
    v_mfma_f32_16x16x32_bf16 v[132:135], a[156:159], a[8:11], v[132:135]
    v_lshlrev_b32 v80, 16, v33
    v_lshlrev_b32 v81, 16, v37
    v_sub_f32 v48, v48, v49
    v_mfma_f32_16x16x32_bf16 v[136:139], a[160:163], a[8:11], v[136:139]
    v_sub_f32 v50, v50, v51
    v_and_b32 v82, s36, v33
    v_mfma_f32_16x16x32_bf16 v[140:143], a[152:155], a[12:15], v[140:143]
    ds_read_b128 a[8:11], v13 offset:44288
    v_and_b32 v83, s36, v37
    v_mfma_f32_16x16x32_bf16 v[144:147], a[156:159], a[12:15], v[144:147]
    v_cvt_pk_bf16_f32 v52, v48, v50
    v_sub_f32 v80, v80, v81
    v_mfma_f32_16x16x32_bf16 v[148:151], a[160:163], a[12:15], v[148:151]
    v_lshlrev_b32 v48, 16, v34
    v_sub_f32 v82, v82, v83
    v_mfma_f32_16x16x32_bf16 v[152:155], a[152:155], a[16:19], v[152:155]
    ds_read_b128 a[12:15], v13 offset:46592
    v_lshlrev_b32 v49, 16, v38
    v_mfma_f32_16x16x32_bf16 v[156:159], a[156:159], a[16:19], v[156:159]
    v_and_b32 v50, s36, v34
    v_and_b32 v51, s36, v38
    v_mfma_f32_16x16x32_bf16 v[160:163], a[160:163], a[16:19], v[160:163]
    s_waitcnt vmcnt(12)
    s_waitcnt lgkmcnt(7)
    v_mfma_f32_16x16x32_bf16 v[252:255], a[188:191], a[20:23], v[252:255]
    ds_read_b128 a[16:19], v14 offset:32768
    s_mov_b32 s31, 614400
    v_mfma_f32_16x16x32_bf16 v[84:87], a[192:195], a[20:23], v[84:87]
    buffer_load_dwordx4 a[152:155], v28, s[20:23], s31 offen offset:0 sc1
    v_mfma_f32_16x16x32_bf16 v[88:91], a[196:199], a[20:23], v[88:91]
    v_cvt_pk_bf16_f32 v53, v80, v82
    v_lshlrev_b32 v80, 16, v35
    v_mfma_f32_16x16x32_bf16 v[92:95], a[188:191], a[24:27], v[92:95]
    ds_read_b128 a[20:23], v14 offset:35072
    v_sub_f32 v48, v48, v49
    v_mfma_f32_16x16x32_bf16 v[96:99], a[192:195], a[24:27], v[96:99]
    buffer_load_dwordx4 a[156:159], v28, s[20:23], s31 offen offset:1024 sc1
    v_mfma_f32_16x16x32_bf16 v[100:103], a[196:199], a[24:27], v[100:103]
    v_lshlrev_b32 v81, 16, v39
    v_sub_f32 v50, v50, v51
    v_mfma_f32_16x16x32_bf16 v[104:107], a[188:191], a[28:31], v[104:107]
    ds_read_b128 a[24:27], v14 offset:37376
    v_and_b32 v82, s36, v35
    v_mfma_f32_16x16x32_bf16 v[108:111], a[192:195], a[28:31], v[108:111]
    buffer_load_dwordx4 a[160:163], v28, s[20:23], s31 offen offset:2048 sc1
    v_mfma_f32_16x16x32_bf16 v[112:115], a[196:199], a[28:31], v[112:115]
    v_and_b32 v83, s36, v39
    s_waitcnt lgkmcnt(4)
    v_mfma_f32_16x16x32_bf16 v[116:119], a[188:191], a[0:3], v[116:119]
L_pad5:
    s_cbranch_vccnz L_pad6
    ds_read_b128 a[28:31], v14 offset:39680
    v_cvt_pk_bf16_f32 v54, v48, v50
    v_mfma_f32_16x16x32_bf16 v[120:123], a[192:195], a[0:3], v[120:123]
    v_sub_f32 v80, v80, v81
    v_sub_f32 v82, v82, v83
    v_mfma_f32_16x16x32_bf16 v[124:127], a[196:199], a[0:3], v[124:127]
    v_cvt_pk_bf16_f32 v55, v80, v82
    v_mfma_f32_16x16x32_bf16 v[128:131], a[188:191], a[4:7], v[128:131]
    ds_read_b128 a[0:3], v14 offset:41984
    v_mfma_f32_16x16x32_bf16 v[132:135], a[192:195], a[4:7], v[132:135]
    ds_write_b64 v18, v[52:53] offset:16384
    v_mfma_f32_16x16x32_bf16 v[136:139], a[196:199], a[4:7], v[136:139]
    ds_write_b64 v18, v[54:55] offset:16392
    v_mfma_f32_16x16x32_bf16 v[140:143], a[188:191], a[8:11], v[140:143]
    ds_read_b128 a[4:7], v14 offset:44288
    ds_read_b128 v[32:35], v24 offset:57600
    v_mfma_f32_16x16x32_bf16 v[144:147], a[192:195], a[8:11], v[144:147]
    ds_read_b128 v[36:39], v24 offset:55296
    v_lshlrev_b32 v48, 16, v40
    v_mfma_f32_16x16x32_bf16 v[148:151], a[196:199], a[8:11], v[148:151]
    v_lshlrev_b32 v49, 16, v44
    s_waitcnt lgkmcnt(8)
    v_mfma_f32_16x16x32_bf16 v[152:155], a[188:191], a[12:15], v[152:155]
    ds_read_b128 a[8:11], v14 offset:46592
    v_and_b32 v50, s36, v40
    v_mfma_f32_16x16x32_bf16 v[156:159], a[192:195], a[12:15], v[156:159]
    v_and_b32 v51, s36, v44
    v_lshlrev_b32 v80, 16, v41
    v_mfma_f32_16x16x32_bf16 v[160:163], a[196:199], a[12:15], v[160:163]
    v_lshlrev_b32 v81, 16, v45
    s_waitcnt vmcnt(12)
    v_mfma_f32_16x16x32_bf16 v[252:255], a[236:239], a[16:19], v[252:255]
    ds_read_b128 a[12:15], v15 offset:32768
    s_mov_b32 s31, 626688
    v_mfma_f32_16x16x32_bf16 v[84:87], a[240:243], a[16:19], v[84:87]
    buffer_load_dwordx4 a[188:191], v28, s[20:23], s31 offen offset:0 sc1
    v_mfma_f32_16x16x32_bf16 v[88:91], a[244:247], a[16:19], v[88:91]
    v_sub_f32 v48, v48, v49
    v_sub_f32 v50, v50, v51
    v_mfma_f32_16x16x32_bf16 v[92:95], a[236:239], a[20:23], v[92:95]
    ds_read_b128 a[16:19], v15 offset:35072
    v_and_b32 v82, s36, v41
    v_mfma_f32_16x16x32_bf16 v[96:99], a[240:243], a[20:23], v[96:99]
    buffer_load_dwordx4 a[192:195], v28, s[20:23], s31 offen offset:1024 sc1
    v_mfma_f32_16x16x32_bf16 v[100:103], a[244:247], a[20:23], v[100:103]
    v_and_b32 v83, s36, v45
    s_waitcnt lgkmcnt(8)
    v_mfma_f32_16x16x32_bf16 v[104:107], a[236:239], a[24:27], v[104:107]
    ds_read_b128 a[20:23], v15 offset:37376
    v_cvt_pk_bf16_f32 v56, v48, v50
    v_mfma_f32_16x16x32_bf16 v[108:111], a[240:243], a[24:27], v[108:111]
    buffer_load_dwordx4 a[196:199], v28, s[20:23], s31 offen offset:2048 sc1
    v_mfma_f32_16x16x32_bf16 v[112:115], a[244:247], a[24:27], v[112:115]
    v_sub_f32 v80, v80, v81
    v_lshlrev_b32 v48, 16, v42
    v_mfma_f32_16x16x32_bf16 v[116:119], a[236:239], a[28:31], v[116:119]
    ds_read_b128 a[24:27], v15 offset:39680
    v_sub_f32 v82, v82, v83
    v_mfma_f32_16x16x32_bf16 v[120:123], a[240:243], a[28:31], v[120:123]
    v_lshlrev_b32 v49, 16, v46
    v_and_b32 v50, s36, v42
    v_mfma_f32_16x16x32_bf16 v[124:127], a[244:247], a[28:31], v[124:127]
    v_and_b32 v51, s36, v46
    v_cvt_pk_bf16_f32 v57, v80, v82
    v_mfma_f32_16x16x32_bf16 v[128:131], a[236:239], a[0:3], v[128:131]
    ds_read_b128 a[28:31], v15 offset:41984
    v_lshlrev_b32 v80, 16, v43
    v_mfma_f32_16x16x32_bf16 v[132:135], a[240:243], a[0:3], v[132:135]
    v_sub_f32 v48, v48, v49
    v_lshlrev_b32 v81, 16, v47
    v_mfma_f32_16x16x32_bf16 v[136:139], a[244:247], a[0:3], v[136:139]
    v_sub_f32 v50, v50, v51
    s_waitcnt lgkmcnt(4)
    v_mfma_f32_16x16x32_bf16 v[140:143], a[236:239], a[4:7], v[140:143]
    ds_read_b128 a[0:3], v15 offset:44288
    v_and_b32 v82, s36, v43
    v_mfma_f32_16x16x32_bf16 v[144:147], a[240:243], a[4:7], v[144:147]
    v_and_b32 v83, s36, v47
    v_cvt_pk_bf16_f32 v58, v48, v50
    v_mfma_f32_16x16x32_bf16 v[148:151], a[244:247], a[4:7], v[148:151]
    v_sub_f32 v80, v80, v81
    v_sub_f32 v82, v82, v83
    v_mfma_f32_16x16x32_bf16 v[152:155], a[236:239], a[8:11], v[152:155]
    ds_read_b128 a[4:7], v15 offset:46592
    v_cvt_pk_bf16_f32 v59, v80, v82
    v_mfma_f32_16x16x32_bf16 v[156:159], a[240:243], a[8:11], v[156:159]
    ds_write_b64 v19, v[56:57] offset:16384
    v_mfma_f32_16x16x32_bf16 v[160:163], a[244:247], a[8:11], v[160:163]
    s_waitcnt vmcnt(12)
    v_mfma_f32_16x16x32_bf16 v[252:255], a[44:47], a[12:15], v[252:255]
    ds_read_b128 a[8:11], v10 offset:0
    s_mov_b32 s31, 638976
    v_mfma_f32_16x16x32_bf16 v[84:87], a[48:51], a[12:15], v[84:87]
    buffer_load_dwordx4 a[236:239], v28, s[20:23], s31 offen offset:0 sc1
    v_mfma_f32_16x16x32_bf16 v[88:91], a[52:55], a[12:15], v[88:91]
    s_waitcnt lgkmcnt(5)
    v_mfma_f32_16x16x32_bf16 v[92:95], a[44:47], a[16:19], v[92:95]
    ds_read_b128 a[12:15], v10 offset:2304
    v_mfma_f32_16x16x32_bf16 v[96:99], a[48:51], a[16:19], v[96:99]
    buffer_load_dwordx4 a[240:243], v28, s[20:23], s31 offen offset:1024 sc1
    v_mfma_f32_16x16x32_bf16 v[100:103], a[52:55], a[16:19], v[100:103]
    ds_write_b64 v19, v[58:59] offset:16392
    v_mfma_f32_16x16x32_bf16 v[104:107], a[44:47], a[20:23], v[104:107]
    ds_read_b128 a[16:19], v10 offset:4608
    ds_read_b128 v[40:43], v25 offset:57600
    v_mfma_f32_16x16x32_bf16 v[108:111], a[48:51], a[20:23], v[108:111]
    buffer_load_dwordx4 a[244:247], v28, s[20:23], s31 offen offset:2048 sc1
    ds_read_b128 v[44:47], v25 offset:55296
    v_mfma_f32_16x16x32_bf16 v[112:115], a[52:55], a[20:23], v[112:115]
    v_lshlrev_b32 v48, 16, v32
    v_lshlrev_b32 v49, 16, v36
    v_mfma_f32_16x16x32_bf16 v[116:119], a[44:47], a[24:27], v[116:119]
    ds_read_b128 a[20:23], v10 offset:6912
    v_and_b32 v50, s36, v32
    v_mfma_f32_16x16x32_bf16 v[120:123], a[48:51], a[24:27], v[120:123]
    v_and_b32 v51, s36, v36
    v_lshlrev_b32 v80, 16, v33
    v_lshlrev_b32 v81, 16, v37
    v_mfma_f32_16x16x32_bf16 v[124:127], a[52:55], a[24:27], v[124:127]
    v_sub_f32 v48, v48, v49
    s_waitcnt lgkmcnt(8)
    v_mfma_f32_16x16x32_bf16 v[128:131], a[44:47], a[28:31], v[128:131]
    ds_read_b128 a[24:27], v10 offset:9216
    v_sub_f32 v50, v50, v51
    v_mfma_f32_16x16x32_bf16 v[132:135], a[48:51], a[28:31], v[132:135]
    v_and_b32 v82, s36, v33
    v_and_b32 v83, s36, v37
    v_cvt_pk_bf16_f32 v52, v48, v50
    v_mfma_f32_16x16x32_bf16 v[136:139], a[52:55], a[28:31], v[136:139]
    v_sub_f32 v80, v80, v81
    v_lshlrev_b32 v48, 16, v34
    v_mfma_f32_16x16x32_bf16 v[140:143], a[44:47], a[0:3], v[140:143]
    ds_read_b128 a[28:31], v10 offset:11520
    v_sub_f32 v82, v82, v83
    v_mfma_f32_16x16x32_bf16 v[144:147], a[48:51], a[0:3], v[144:147]
    v_lshlrev_b32 v49, 16, v38
    v_and_b32 v50, s36, v34
    v_mfma_f32_16x16x32_bf16 v[148:151], a[52:55], a[0:3], v[148:151]
    v_and_b32 v51, s36, v38
    v_cvt_pk_bf16_f32 v53, v80, v82
    v_mfma_f32_16x16x32_bf16 v[152:155], a[44:47], a[4:7], v[152:155]
    ds_read_b128 a[0:3], v10 offset:13824
    v_lshlrev_b32 v80, 16, v35
    v_mfma_f32_16x16x32_bf16 v[156:159], a[48:51], a[4:7], v[156:159]
    v_sub_f32 v48, v48, v49
    v_lshlrev_b32 v81, 16, v39
    v_mfma_f32_16x16x32_bf16 v[160:163], a[52:55], a[4:7], v[160:163]
    s_waitcnt lgkmcnt(7)
    s_barrier
    s_waitcnt vmcnt(12)
    v_mfma_f32_16x16x32_bf16 v[168:171], a[80:83], a[8:11], v[168:171]
    ds_read_b128 a[4:7], v11 offset:0
    s_mov_b32 s31, 651264
    v_mfma_f32_16x16x32_bf16 v[172:175], a[84:87], a[8:11], v[172:175]
    buffer_load_dwordx4 a[44:47], v28, s[20:23], s31 offen offset:0 sc1
    v_mfma_f32_16x16x32_bf16 v[176:179], a[88:91], a[8:11], v[176:179]
    v_sub_f32 v50, v50, v51
    v_and_b32 v82, s36, v35
    v_mfma_f32_16x16x32_bf16 v[180:183], a[80:83], a[12:15], v[180:183]
    ds_read_b128 a[8:11], v11 offset:2304
    v_and_b32 v83, s36, v39
    v_mfma_f32_16x16x32_bf16 v[184:187], a[84:87], a[12:15], v[184:187]
    buffer_load_dwordx4 a[48:51], v28, s[20:23], s31 offen offset:1024 sc1
    v_mfma_f32_16x16x32_bf16 v[188:191], a[88:91], a[12:15], v[188:191]
    v_cvt_pk_bf16_f32 v54, v48, v50
    s_waitcnt lgkmcnt(4)
    v_mfma_f32_16x16x32_bf16 v[192:195], a[80:83], a[16:19], v[192:195]
    ds_read_b128 a[12:15], v11 offset:4608
    v_sub_f32 v80, v80, v81
    v_mfma_f32_16x16x32_bf16 v[196:199], a[84:87], a[16:19], v[196:199]
    buffer_load_dwordx4 a[52:55], v28, s[20:23], s31 offen offset:2048 sc1
    v_mfma_f32_16x16x32_bf16 v[200:203], a[88:91], a[16:19], v[200:203]
    v_sub_f32 v82, v82, v83
    v_cvt_pk_bf16_f32 v55, v80, v82
    v_mfma_f32_16x16x32_bf16 v[204:207], a[80:83], a[20:23], v[204:207]
    ds_read_b128 a[16:19], v11 offset:6912
    v_cvt_pk_bf16_f32 v60, v252, v253
    v_mfma_f32_16x16x32_bf16 v[208:211], a[84:87], a[20:23], v[208:211]
    ds_write_b64 v16, v[52:53] offset:32768
    v_mfma_f32_16x16x32_bf16 v[212:215], a[88:91], a[20:23], v[212:215]
    ds_write_b64 v16, v[54:55] offset:32776
    v_mfma_f32_16x16x32_bf16 v[216:219], a[80:83], a[24:27], v[216:219]
    ds_read_b128 a[20:23], v11 offset:9216
    ds_read_b128 v[32:35], v26 offset:57600
    v_mfma_f32_16x16x32_bf16 v[220:223], a[84:87], a[24:27], v[220:223]
    ds_read_b128 v[36:39], v26 offset:55296
    v_lshlrev_b32 v48, 16, v40
    v_mfma_f32_16x16x32_bf16 v[224:227], a[88:91], a[24:27], v[224:227]
    v_lshlrev_b32 v49, 16, v44
    s_waitcnt lgkmcnt(8)
    v_mfma_f32_16x16x32_bf16 v[228:231], a[80:83], a[28:31], v[228:231]
    ds_read_b128 a[24:27], v11 offset:11520
    v_and_b32 v50, s36, v40
    v_mfma_f32_16x16x32_bf16 v[232:235], a[84:87], a[28:31], v[232:235]
    v_and_b32 v51, s36, v44
    v_lshlrev_b32 v80, 16, v41
    v_mfma_f32_16x16x32_bf16 v[236:239], a[88:91], a[28:31], v[236:239]
    v_lshlrev_b32 v81, 16, v45
    v_sub_f32 v48, v48, v49
    v_mfma_f32_16x16x32_bf16 v[240:243], a[80:83], a[0:3], v[240:243]
    ds_read_b128 a[28:31], v11 offset:13824
    v_sub_f32 v50, v50, v51
    v_mfma_f32_16x16x32_bf16 v[244:247], a[84:87], a[0:3], v[244:247]
    v_and_b32 v82, s36, v41
    v_and_b32 v83, s36, v45
    v_mfma_f32_16x16x32_bf16 v[248:251], a[88:91], a[0:3], v[248:251]
    v_cvt_pk_bf16_f32 v56, v48, v50
    s_waitcnt vmcnt(12)
    v_mfma_f32_16x16x32_bf16 v[168:171], a[92:95], a[4:7], v[168:171]
    ds_read_b128 a[0:3], v12 offset:0
    v_sub_f32 v80, v80, v81
    v_mfma_f32_16x16x32_bf16 v[172:175], a[96:99], a[4:7], v[172:175]
    v_lshlrev_b32 v48, 16, v42
    v_sub_f32 v82, v82, v83
    v_mfma_f32_16x16x32_bf16 v[176:179], a[100:103], a[4:7], v[176:179]
    v_lshlrev_b32 v49, 16, v46
    s_waitcnt lgkmcnt(8)
    v_mfma_f32_16x16x32_bf16 v[180:183], a[92:95], a[8:11], v[180:183]
    ds_read_b128 a[4:7], v12 offset:2304
    v_and_b32 v50, s36, v42
    v_mfma_f32_16x16x32_bf16 v[184:187], a[96:99], a[8:11], v[184:187]
    v_and_b32 v51, s36, v46
    v_cvt_pk_bf16_f32 v57, v80, v82
    v_mfma_f32_16x16x32_bf16 v[188:191], a[100:103], a[8:11], v[188:191]
    v_lshlrev_b32 v80, 16, v43
    v_sub_f32 v48, v48, v49
    v_mfma_f32_16x16x32_bf16 v[192:195], a[92:95], a[12:15], v[192:195]
    ds_read_b128 a[8:11], v12 offset:4608
    v_lshlrev_b32 v81, 16, v47
    v_mfma_f32_16x16x32_bf16 v[196:199], a[96:99], a[12:15], v[196:199]
    v_sub_f32 v50, v50, v51
    v_and_b32 v82, s36, v43
    v_mfma_f32_16x16x32_bf16 v[200:203], a[100:103], a[12:15], v[200:203]
    v_and_b32 v83, s36, v47
    v_cvt_pk_bf16_f32 v58, v48, v50
    v_mfma_f32_16x16x32_bf16 v[204:207], a[92:95], a[16:19], v[204:207]
    ds_read_b128 a[12:15], v12 offset:6912
    v_sub_f32 v80, v80, v81
    v_mfma_f32_16x16x32_bf16 v[208:211], a[96:99], a[16:19], v[208:211]
    v_sub_f32 v82, v82, v83
    v_cvt_pk_bf16_f32 v59, v80, v82
    v_mfma_f32_16x16x32_bf16 v[212:215], a[100:103], a[16:19], v[212:215]
    v_cvt_pk_bf16_f32 v61, v254, v255
    s_waitcnt lgkmcnt(4)
    v_mfma_f32_16x16x32_bf16 v[216:219], a[92:95], a[20:23], v[216:219]
    ds_read_b128 a[16:19], v12 offset:9216
    v_cvt_pk_bf16_f32 v62, v84, v85
    v_mfma_f32_16x16x32_bf16 v[220:223], a[96:99], a[20:23], v[220:223]
    ds_write_b64 v17, v[56:57] offset:32768
    v_mfma_f32_16x16x32_bf16 v[224:227], a[100:103], a[20:23], v[224:227]
    ds_write_b64 v17, v[58:59] offset:32776
    v_mfma_f32_16x16x32_bf16 v[228:231], a[92:95], a[24:27], v[228:231]
    ds_read_b128 a[20:23], v12 offset:11520
    ds_read_b128 v[40:43], v27 offset:57600
    v_mfma_f32_16x16x32_bf16 v[232:235], a[96:99], a[24:27], v[232:235]
    ds_read_b128 v[44:47], v27 offset:55296
    v_lshlrev_b32 v48, 16, v32
    v_mfma_f32_16x16x32_bf16 v[236:239], a[100:103], a[24:27], v[236:239]
    v_lshlrev_b32 v49, 16, v36
    v_and_b32 v50, s36, v32
    v_mfma_f32_16x16x32_bf16 v[240:243], a[92:95], a[28:31], v[240:243]
    ds_read_b128 a[24:27], v12 offset:13824
    v_and_b32 v51, s36, v36
    v_mfma_f32_16x16x32_bf16 v[244:247], a[96:99], a[28:31], v[244:247]
    v_lshlrev_b32 v80, 16, v33
    v_lshlrev_b32 v81, 16, v37
    v_mfma_f32_16x16x32_bf16 v[248:251], a[100:103], a[28:31], v[248:251]
    s_waitcnt vmcnt(9)
    s_waitcnt lgkmcnt(8)
    v_mfma_f32_16x16x32_bf16 v[168:171], a[152:155], a[0:3], v[168:171]
    ds_read_b128 a[28:31], v13 offset:0
    v_sub_f32 v48, v48, v49
    v_mfma_f32_16x16x32_bf16 v[172:175], a[156:159], a[0:3], v[172:175]
    v_sub_f32 v50, v50, v51
    v_and_b32 v82, s36, v33
    v_mfma_f32_16x16x32_bf16 v[176:179], a[160:163], a[0:3], v[176:179]
    v_and_b32 v83, s36, v37
    v_cvt_pk_bf16_f32 v52, v48, v50
    v_mfma_f32_16x16x32_bf16 v[180:183], a[152:155], a[4:7], v[180:183]
    ds_read_b128 a[0:3], v13 offset:2304
    v_sub_f32 v80, v80, v81
    v_mfma_f32_16x16x32_bf16 v[184:187], a[156:159], a[4:7], v[184:187]
    v_lshlrev_b32 v48, 16, v34
    v_sub_f32 v82, v82, v83
    v_mfma_f32_16x16x32_bf16 v[188:191], a[160:163], a[4:7], v[188:191]
    v_lshlrev_b32 v49, 16, v38
    v_and_b32 v50, s36, v34
    v_mfma_f32_16x16x32_bf16 v[192:195], a[152:155], a[8:11], v[192:195]
    ds_read_b128 a[4:7], v13 offset:4608
    v_and_b32 v51, s36, v38
    v_mfma_f32_16x16x32_bf16 v[196:199], a[156:159], a[8:11], v[196:199]
    v_cvt_pk_bf16_f32 v53, v80, v82
    v_lshlrev_b32 v80, 16, v35
    v_mfma_f32_16x16x32_bf16 v[200:203], a[160:163], a[8:11], v[200:203]
    v_sub_f32 v48, v48, v49
    s_waitcnt lgkmcnt(6)
    v_mfma_f32_16x16x32_bf16 v[204:207], a[152:155], a[12:15], v[204:207]
    ds_read_b128 a[8:11], v13 offset:6912
    v_lshlrev_b32 v81, 16, v39
    v_mfma_f32_16x16x32_bf16 v[208:211], a[156:159], a[12:15], v[208:211]
    v_sub_f32 v50, v50, v51
    v_and_b32 v82, s36, v35
    v_mfma_f32_16x16x32_bf16 v[212:215], a[160:163], a[12:15], v[212:215]
    v_and_b32 v83, s36, v39
    v_cvt_pk_bf16_f32 v54, v48, v50
    v_mfma_f32_16x16x32_bf16 v[216:219], a[152:155], a[16:19], v[216:219]
    ds_read_b128 a[12:15], v13 offset:9216
    v_sub_f32 v80, v80, v81
    v_mfma_f32_16x16x32_bf16 v[220:223], a[156:159], a[16:19], v[220:223]
    v_sub_f32 v82, v82, v83
    v_cvt_pk_bf16_f32 v55, v80, v82
    v_mfma_f32_16x16x32_bf16 v[224:227], a[160:163], a[16:19], v[224:227]
    ds_write_b64 v18, v[52:53] offset:32768
    v_mfma_f32_16x16x32_bf16 v[228:231], a[152:155], a[20:23], v[228:231]
    ds_read_b128 a[16:19], v13 offset:11520
    v_cvt_pk_bf16_f32 v63, v86, v87
    v_mfma_f32_16x16x32_bf16 v[232:235], a[156:159], a[20:23], v[232:235]
    ds_write_b64 v18, v[54:55] offset:32776
    v_mfma_f32_16x16x32_bf16 v[236:239], a[160:163], a[20:23], v[236:239]
    s_mov_b32 s34, 0
    s_waitcnt lgkmcnt(6)
    v_mfma_f32_16x16x32_bf16 v[240:243], a[152:155], a[24:27], v[240:243]
    ds_read_b128 a[20:23], v13 offset:13824
    v_lshlrev_b32 v48, 16, v40
    v_mfma_f32_16x16x32_bf16 v[244:247], a[156:159], a[24:27], v[244:247]
    v_lshlrev_b32 v49, 16, v44
    v_and_b32 v50, s36, v40
    v_mfma_f32_16x16x32_bf16 v[248:251], a[160:163], a[24:27], v[248:251]
    v_and_b32 v51, s36, v44
    s_waitcnt vmcnt(6)
    v_mfma_f32_16x16x32_bf16 v[168:171], a[188:191], a[28:31], v[168:171]
    ds_read_b128 a[24:27], v14 offset:0
    v_lshlrev_b32 v80, 16, v41
    v_mfma_f32_16x16x32_bf16 v[172:175], a[192:195], a[28:31], v[172:175]
    v_lshlrev_b32 v81, 16, v45
    v_sub_f32 v48, v48, v49
    v_mfma_f32_16x16x32_bf16 v[176:179], a[196:199], a[28:31], v[176:179]
    v_sub_f32 v50, v50, v51
    v_and_b32 v82, s36, v41
    v_mfma_f32_16x16x32_bf16 v[180:183], a[188:191], a[0:3], v[180:183]
    ds_read_b128 a[28:31], v14 offset:2304
    v_and_b32 v83, s36, v45
    v_mfma_f32_16x16x32_bf16 v[184:187], a[192:195], a[0:3], v[184:187]
    v_cvt_pk_bf16_f32 v56, v48, v50
    v_sub_f32 v80, v80, v81
    v_mfma_f32_16x16x32_bf16 v[188:191], a[196:199], a[0:3], v[188:191]
    v_lshlrev_b32 v48, 16, v42
    s_waitcnt lgkmcnt(6)
    v_mfma_f32_16x16x32_bf16 v[192:195], a[188:191], a[4:7], v[192:195]
    ds_read_b128 a[0:3], v14 offset:4608
    v_sub_f32 v82, v82, v83
    v_mfma_f32_16x16x32_bf16 v[196:199], a[192:195], a[4:7], v[196:199]
    v_lshlrev_b32 v49, 16, v46
    v_and_b32 v50, s36, v42
    v_mfma_f32_16x16x32_bf16 v[200:203], a[196:199], a[4:7], v[200:203]
    v_and_b32 v51, s36, v46
    v_cvt_pk_bf16_f32 v57, v80, v82
    v_mfma_f32_16x16x32_bf16 v[204:207], a[188:191], a[8:11], v[204:207]
    ds_read_b128 a[4:7], v14 offset:6912
    v_lshlrev_b32 v80, 16, v43
    v_mfma_f32_16x16x32_bf16 v[208:211], a[192:195], a[8:11], v[208:211]
    v_sub_f32 v48, v48, v49
    v_lshlrev_b32 v81, 16, v47
    v_mfma_f32_16x16x32_bf16 v[212:215], a[196:199], a[8:11], v[212:215]
    v_sub_f32 v50, v50, v51
    v_and_b32 v82, s36, v43
    v_mfma_f32_16x16x32_bf16 v[216:219], a[188:191], a[12:15], v[216:219]
    ds_read_b128 a[8:11], v14 offset:9216
    v_and_b32 v83, s36, v47
    v_mfma_f32_16x16x32_bf16 v[220:223], a[192:195], a[12:15], v[220:223]
    v_cvt_pk_bf16_f32 v58, v48, v50
    v_sub_f32 v80, v80, v81
    v_mfma_f32_16x16x32_bf16 v[224:227], a[196:199], a[12:15], v[224:227]
    v_sub_f32 v82, v82, v83
    s_waitcnt lgkmcnt(4)
    v_mfma_f32_16x16x32_bf16 v[228:231], a[188:191], a[16:19], v[228:231]
    ds_read_b128 a[12:15], v14 offset:11520
    v_cvt_pk_bf16_f32 v59, v80, v82
    v_mfma_f32_16x16x32_bf16 v[232:235], a[192:195], a[16:19], v[232:235]
    ds_write_b64 v19, v[56:57] offset:32768
    v_mfma_f32_16x16x32_bf16 v[236:239], a[196:199], a[16:19], v[236:239]
    ds_write_b64 v19, v[58:59] offset:32776
    v_mfma_f32_16x16x32_bf16 v[240:243], a[188:191], a[20:23], v[240:243]
    ds_read_b128 a[16:19], v14 offset:13824
    v_cvt_pk_bf16_f32 v68, v88, v89
    v_mfma_f32_16x16x32_bf16 v[244:247], a[192:195], a[20:23], v[244:247]
    v_cvt_pk_bf16_f32 v69, v90, v91
    buffer_store_dwordx4 v[60:63], v29, s[24:27], s34 offen nt
    v_mfma_f32_16x16x32_bf16 v[248:251], a[196:199], a[20:23], v[248:251]
    v_cvt_pk_bf16_f32 v64, v92, v93
    s_waitcnt vmcnt(4)
    v_mfma_f32_16x16x32_bf16 v[168:171], a[236:239], a[24:27], v[168:171]
    ds_read_b128 a[20:23], v15 offset:0
    v_cvt_pk_bf16_f32 v65, v94, v95
    v_mfma_f32_16x16x32_bf16 v[172:175], a[240:243], a[24:27], v[172:175]
    v_cvt_pk_bf16_f32 v66, v96, v97
    v_cvt_pk_bf16_f32 v67, v98, v99
    v_mfma_f32_16x16x32_bf16 v[176:179], a[244:247], a[24:27], v[176:179]
    s_mov_b32 s34, 344064
    s_waitcnt lgkmcnt(6)
    v_mfma_f32_16x16x32_bf16 v[180:183], a[236:239], a[28:31], v[180:183]
    ds_read_b128 a[24:27], v15 offset:2304
    v_cvt_pk_bf16_f32 v70, v100, v101
    v_mfma_f32_16x16x32_bf16 v[184:187], a[240:243], a[28:31], v[184:187]
    v_cvt_pk_bf16_f32 v71, v102, v103
    buffer_store_dwordx4 v[64:67], v29, s[24:27], s34 offen nt
    v_mfma_f32_16x16x32_bf16 v[188:191], a[244:247], a[28:31], v[188:191]
    s_mov_b32 s34, 0
    s_nop 0
    v_mfma_f32_16x16x32_bf16 v[192:195], a[236:239], a[0:3], v[192:195]
    ds_read_b128 a[28:31], v15 offset:4608
    v_permlane16_swap_b32 v68, v70
    v_mfma_f32_16x16x32_bf16 v[196:199], a[240:243], a[0:3], v[196:199]
    v_permlane16_swap_b32 v69, v71
    buffer_store_dwordx4 v[68:71], v30, s[24:27], s34 offen nt
    v_mfma_f32_16x16x32_bf16 v[200:203], a[244:247], a[0:3], v[200:203]
    v_cvt_pk_bf16_f32 v60, v104, v105
    v_cvt_pk_bf16_f32 v61, v106, v107
    v_mfma_f32_16x16x32_bf16 v[204:207], a[236:239], a[4:7], v[204:207]
    ds_read_b128 a[0:3], v15 offset:6912
    v_cvt_pk_bf16_f32 v62, v108, v109
    v_mfma_f32_16x16x32_bf16 v[208:211], a[240:243], a[4:7], v[208:211]
    v_cvt_pk_bf16_f32 v63, v110, v111
    s_mov_b32 s34, 688128
    v_mfma_f32_16x16x32_bf16 v[212:215], a[244:247], a[4:7], v[212:215]
    v_cvt_pk_bf16_f32 v72, v112, v113
    s_waitcnt lgkmcnt(4)
    v_mfma_f32_16x16x32_bf16 v[216:219], a[236:239], a[8:11], v[216:219]
    ds_read_b128 a[4:7], v15 offset:9216
    v_cvt_pk_bf16_f32 v73, v114, v115
    v_mfma_f32_16x16x32_bf16 v[220:223], a[240:243], a[8:11], v[220:223]
    buffer_store_dwordx4 v[60:63], v29, s[24:27], s34 offen nt
    v_cvt_pk_bf16_f32 v64, v116, v117
    v_mfma_f32_16x16x32_bf16 v[224:227], a[244:247], a[8:11], v[224:227]
    v_cvt_pk_bf16_f32 v65, v118, v119
    v_cvt_pk_bf16_f32 v66, v120, v121
    v_mfma_f32_16x16x32_bf16 v[228:231], a[236:239], a[12:15], v[228:231]
    ds_read_b128 a[8:11], v15 offset:11520
    v_cvt_pk_bf16_f32 v67, v122, v123
    v_mfma_f32_16x16x32_bf16 v[232:235], a[240:243], a[12:15], v[232:235]
    s_mov_b32 s34, 1032192
    v_cvt_pk_bf16_f32 v74, v124, v125
    v_mfma_f32_16x16x32_bf16 v[236:239], a[244:247], a[12:15], v[236:239]
    v_cvt_pk_bf16_f32 v75, v126, v127
    v_mfma_f32_16x16x32_bf16 v[240:243], a[236:239], a[16:19], v[240:243]
    ds_read_b128 a[12:15], v15 offset:13824
    v_mfma_f32_16x16x32_bf16 v[244:247], a[240:243], a[16:19], v[244:247]
    v_mfma_f32_16x16x32_bf16 v[248:251], a[244:247], a[16:19], v[248:251]
    s_waitcnt vmcnt(4)
    s_waitcnt lgkmcnt(4)
    v_mfma_f32_16x16x32_bf16 v[168:171], a[44:47], a[20:23], v[168:171]
    ds_read_b128 a[16:19], v10 offset:16384
    v_mfma_f32_16x16x32_bf16 v[172:175], a[48:51], a[20:23], v[172:175]
    v_mfma_f32_16x16x32_bf16 v[176:179], a[52:55], a[20:23], v[176:179]
    v_mfma_f32_16x16x32_bf16 v[180:183], a[44:47], a[24:27], v[180:183]
    ds_read_b128 a[20:23], v11 offset:16384
    v_mfma_f32_16x16x32_bf16 v[184:187], a[48:51], a[24:27], v[184:187]
    v_mfma_f32_16x16x32_bf16 v[188:191], a[52:55], a[24:27], v[188:191]
    v_mfma_f32_16x16x32_bf16 v[192:195], a[44:47], a[28:31], v[192:195]
    ds_read_b128 a[24:27], v12 offset:16384
    v_mfma_f32_16x16x32_bf16 v[196:199], a[48:51], a[28:31], v[196:199]
    v_mfma_f32_16x16x32_bf16 v[200:203], a[52:55], a[28:31], v[200:203]
    s_waitcnt lgkmcnt(4)
    v_mfma_f32_16x16x32_bf16 v[204:207], a[44:47], a[0:3], v[204:207]
    ds_read_b128 a[28:31], v13 offset:16384
    buffer_store_dwordx4 v[64:67], v29, s[24:27], s34 offen nt
    v_mfma_f32_16x16x32_bf16 v[208:211], a[48:51], a[0:3], v[208:211]
    s_mov_b32 s34, 688128
    s_nop 0
    v_mfma_f32_16x16x32_bf16 v[212:215], a[52:55], a[0:3], v[212:215]
    v_permlane16_swap_b32 v72, v74
    v_permlane16_swap_b32 v73, v75
    v_mfma_f32_16x16x32_bf16 v[216:219], a[44:47], a[4:7], v[216:219]
    ds_read_b128 a[0:3], v14 offset:16384
    v_mfma_f32_16x16x32_bf16 v[220:223], a[48:51], a[4:7], v[220:223]
    v_mfma_f32_16x16x32_bf16 v[224:227], a[52:55], a[4:7], v[224:227]
    v_mfma_f32_16x16x32_bf16 v[228:231], a[44:47], a[8:11], v[228:231]
    ds_read_b128 a[4:7], v15 offset:16384
    v_mfma_f32_16x16x32_bf16 v[232:235], a[48:51], a[8:11], v[232:235]
    v_mfma_f32_16x16x32_bf16 v[236:239], a[52:55], a[8:11], v[236:239]
    s_waitcnt lgkmcnt(4)
    v_mfma_f32_16x16x32_bf16 v[240:243], a[44:47], a[12:15], v[240:243]
    ds_read_b128 a[8:11], v10 offset:32768
    v_mfma_f32_16x16x32_bf16 v[244:247], a[48:51], a[12:15], v[244:247]
    v_mfma_f32_16x16x32_bf16 v[248:251], a[52:55], a[12:15], v[248:251]
    s_barrier
    v_mfma_f32_16x16x32_bf16 v[168:171], a[104:107], a[16:19], v[168:171]
    ds_read_b128 a[12:15], v11 offset:32768
    v_mfma_f32_16x16x32_bf16 v[172:175], a[108:111], a[16:19], v[172:175]
    v_mfma_f32_16x16x32_bf16 v[176:179], a[112:115], a[16:19], v[176:179]
    v_mfma_f32_16x16x32_bf16 v[168:171], a[140:143], a[20:23], v[168:171]
    ds_read_b128 a[16:19], v12 offset:32768
    v_mfma_f32_16x16x32_bf16 v[172:175], a[144:147], a[20:23], v[172:175]
    v_mfma_f32_16x16x32_bf16 v[176:179], a[148:151], a[20:23], v[176:179]
    s_waitcnt lgkmcnt(4)
    v_mfma_f32_16x16x32_bf16 v[168:171], a[176:179], a[24:27], v[168:171]
    ds_read_b128 a[20:23], v13 offset:32768
    v_mfma_f32_16x16x32_bf16 v[172:175], a[180:183], a[24:27], v[172:175]
    v_mfma_f32_16x16x32_bf16 v[176:179], a[184:187], a[24:27], v[176:179]
    v_mfma_f32_16x16x32_bf16 v[168:171], a[212:215], a[28:31], v[168:171]
    ds_read_b128 a[24:27], v14 offset:32768
    v_mfma_f32_16x16x32_bf16 v[172:175], a[216:219], a[28:31], v[172:175]
    v_mfma_f32_16x16x32_bf16 v[176:179], a[220:223], a[28:31], v[176:179]
    v_mfma_f32_16x16x32_bf16 v[168:171], a[32:35], a[0:3], v[168:171]
    ds_read_b128 a[28:31], v15 offset:32768
    buffer_store_dwordx4 v[72:75], v30, s[24:27], s34 offen nt
    v_mfma_f32_16x16x32_bf16 v[172:175], a[36:39], a[0:3], v[172:175]
    v_cvt_pk_bf16_f32 v60, v128, v129
    v_cvt_pk_bf16_f32 v61, v130, v131
    v_mfma_f32_16x16x32_bf16 v[176:179], a[40:43], a[0:3], v[176:179]
    v_cvt_pk_bf16_f32 v62, v132, v133
    s_waitcnt lgkmcnt(4)
    v_mfma_f32_16x16x32_bf16 v[168:171], a[68:71], a[4:7], v[168:171]
    ds_read_b128 a[0:3], v10 offset:18688
    v_cvt_pk_bf16_f32 v63, v134, v135
    v_mfma_f32_16x16x32_bf16 v[172:175], a[72:75], a[4:7], v[172:175]
    s_mov_b32 s34, 1376256
    v_cvt_pk_bf16_f32 v68, v136, v137
    v_mfma_f32_16x16x32_bf16 v[176:179], a[76:79], a[4:7], v[176:179]
    v_cvt_pk_bf16_f32 v69, v138, v139
    v_mfma_f32_16x16x32_bf16 v[168:171], a[116:119], a[8:11], v[168:171]
    ds_read_b128 a[4:7], v11 offset:18688
    v_mfma_f32_16x16x32_bf16 v[172:175], a[120:123], a[8:11], v[172:175]
    v_mfma_f32_16x16x32_bf16 v[176:179], a[124:127], a[8:11], v[176:179]
    v_mfma_f32_16x16x32_bf16 v[168:171], a[164:167], a[12:15], v[168:171]
    ds_read_b128 a[8:11], v12 offset:18688
    v_mfma_f32_16x16x32_bf16 v[172:175], a[168:171], a[12:15], v[172:175]
    v_mfma_f32_16x16x32_bf16 v[176:179], a[172:175], a[12:15], v[176:179]
    s_waitcnt lgkmcnt(4)
    v_mfma_f32_16x16x32_bf16 v[168:171], a[224:227], a[16:19], v[168:171]
    ds_read_b128 a[12:15], v13 offset:18688
    v_mfma_f32_16x16x32_bf16 v[172:175], a[228:231], a[16:19], v[172:175]
    v_mfma_f32_16x16x32_bf16 v[176:179], a[232:235], a[16:19], v[176:179]
    v_mfma_f32_16x16x32_bf16 v[168:171], a[56:59], a[20:23], v[168:171]
    ds_read_b128 a[16:19], v14 offset:18688
    v_mfma_f32_16x16x32_bf16 v[172:175], a[60:63], a[20:23], v[172:175]
    v_mfma_f32_16x16x32_bf16 v[176:179], a[64:67], a[20:23], v[176:179]
    v_mfma_f32_16x16x32_bf16 v[168:171], a[128:131], a[24:27], v[168:171]
    ds_read_b128 a[20:23], v15 offset:18688
    v_mfma_f32_16x16x32_bf16 v[172:175], a[132:135], a[24:27], v[172:175]
    v_mfma_f32_16x16x32_bf16 v[176:179], a[136:139], a[24:27], v[176:179]
    s_waitcnt lgkmcnt(4)
    v_mfma_f32_16x16x32_bf16 v[168:171], a[200:203], a[28:31], v[168:171]
    ds_read_b128 a[24:27], v10 offset:35072
    buffer_store_dwordx4 v[60:63], v29, s[24:27], s34 offen nt
    v_mfma_f32_16x16x32_bf16 v[172:175], a[204:207], a[28:31], v[172:175]
    v_cvt_pk_bf16_f32 v64, v140, v141
    v_cvt_pk_bf16_f32 v65, v142, v143
    v_mfma_f32_16x16x32_bf16 v[176:179], a[208:211], a[28:31], v[176:179]
    v_cvt_pk_bf16_f32 v66, v144, v145
    v_cvt_pk_bf16_f32 v67, v146, v147
    v_mfma_f32_16x16x32_bf16 v[180:183], a[104:107], a[0:3], v[180:183]
    ds_read_b128 a[28:31], v11 offset:35072
    s_mov_b32 s34, 1720320
    v_mfma_f32_16x16x32_bf16 v[184:187], a[108:111], a[0:3], v[184:187]
    v_cvt_pk_bf16_f32 v70, v148, v149
    v_cvt_pk_bf16_f32 v71, v150, v151
    v_mfma_f32_16x16x32_bf16 v[188:191], a[112:115], a[0:3], v[188:191]
    v_mfma_f32_16x16x32_bf16 v[180:183], a[140:143], a[4:7], v[180:183]
    ds_read_b128 a[0:3], v12 offset:35072
    v_cvt_pk_bf16_f32 v32, v168, v169
    v_mfma_f32_16x16x32_bf16 v[184:187], a[144:147], a[4:7], v[184:187]
    v_cvt_pk_bf16_f32 v33, v170, v171
    v_cvt_pk_bf16_f32 v34, v172, v173
    v_mfma_f32_16x16x32_bf16 v[188:191], a[148:151], a[4:7], v[188:191]
    v_cvt_pk_bf16_f32 v35, v174, v175
    s_waitcnt lgkmcnt(4)
    v_mfma_f32_16x16x32_bf16 v[180:183], a[176:179], a[8:11], v[180:183]
    ds_read_b128 a[4:7], v13 offset:35072
    s_mov_b32 s38, 172032
    v_mfma_f32_16x16x32_bf16 v[184:187], a[180:183], a[8:11], v[184:187]
    v_cvt_pk_bf16_f32 v40, v176, v177
    v_cvt_pk_bf16_f32 v41, v178, v179
    v_mfma_f32_16x16x32_bf16 v[188:191], a[184:187], a[8:11], v[188:191]
    buffer_store_dwordx4 v[32:35], v29, s[24:27], s38 offen
    v_mfma_f32_16x16x32_bf16 v[180:183], a[212:215], a[12:15], v[180:183]
    ds_read_b128 a[8:11], v14 offset:35072
    v_mfma_f32_16x16x32_bf16 v[184:187], a[216:219], a[12:15], v[184:187]
    v_mfma_f32_16x16x32_bf16 v[188:191], a[220:223], a[12:15], v[188:191]
    v_mfma_f32_16x16x32_bf16 v[180:183], a[32:35], a[16:19], v[180:183]
    ds_read_b128 a[12:15], v15 offset:35072
    v_mfma_f32_16x16x32_bf16 v[184:187], a[36:39], a[16:19], v[184:187]
    v_mfma_f32_16x16x32_bf16 v[188:191], a[40:43], a[16:19], v[188:191]
    s_waitcnt lgkmcnt(4)
    v_mfma_f32_16x16x32_bf16 v[180:183], a[68:71], a[20:23], v[180:183]
    ds_read_b128 a[16:19], v10 offset:20992
    v_mfma_f32_16x16x32_bf16 v[184:187], a[72:75], a[20:23], v[184:187]
    v_mfma_f32_16x16x32_bf16 v[188:191], a[76:79], a[20:23], v[188:191]
    v_mfma_f32_16x16x32_bf16 v[180:183], a[116:119], a[24:27], v[180:183]
    ds_read_b128 a[20:23], v11 offset:20992
    v_mfma_f32_16x16x32_bf16 v[184:187], a[120:123], a[24:27], v[184:187]
    v_mfma_f32_16x16x32_bf16 v[188:191], a[124:127], a[24:27], v[188:191]
    v_mfma_f32_16x16x32_bf16 v[180:183], a[164:167], a[28:31], v[180:183]
    ds_read_b128 a[24:27], v12 offset:20992
    buffer_store_dwordx4 v[64:67], v29, s[24:27], s34 offen nt
L_pad6:
    s_cbranch_vccnz L_tourend
    v_mfma_f32_16x16x32_bf16 v[184:187], a[168:171], a[28:31], v[184:187]
    s_mov_b32 s34, 1376256
    s_nop 0
    v_mfma_f32_16x16x32_bf16 v[188:191], a[172:175], a[28:31], v[188:191]
    v_permlane16_swap_b32 v68, v70
    s_waitcnt lgkmcnt(4)
    v_mfma_f32_16x16x32_bf16 v[180:183], a[224:227], a[0:3], v[180:183]
    ds_read_b128 a[28:31], v13 offset:20992
    v_permlane16_swap_b32 v69, v71
    v_mfma_f32_16x16x32_bf16 v[184:187], a[228:231], a[0:3], v[184:187]
    v_mfma_f32_16x16x32_bf16 v[188:191], a[232:235], a[0:3], v[188:191]
    v_mfma_f32_16x16x32_bf16 v[180:183], a[56:59], a[4:7], v[180:183]
    ds_read_b128 a[0:3], v14 offset:20992
    v_mfma_f32_16x16x32_bf16 v[184:187], a[60:63], a[4:7], v[184:187]
    v_mfma_f32_16x16x32_bf16 v[188:191], a[64:67], a[4:7], v[188:191]
    v_mfma_f32_16x16x32_bf16 v[180:183], a[128:131], a[8:11], v[180:183]
    ds_read_b128 a[4:7], v15 offset:20992
    v_mfma_f32_16x16x32_bf16 v[184:187], a[132:135], a[8:11], v[184:187]
    v_mfma_f32_16x16x32_bf16 v[188:191], a[136:139], a[8:11], v[188:191]
    s_waitcnt lgkmcnt(4)
    v_mfma_f32_16x16x32_bf16 v[180:183], a[200:203], a[12:15], v[180:183]
    ds_read_b128 a[8:11], v10 offset:37376
    v_mfma_f32_16x16x32_bf16 v[184:187], a[204:207], a[12:15], v[184:187]
    v_mfma_f32_16x16x32_bf16 v[188:191], a[208:211], a[12:15], v[188:191]
    v_mfma_f32_16x16x32_bf16 v[192:195], a[104:107], a[16:19], v[192:195]
    ds_read_b128 a[12:15], v11 offset:37376
    v_mfma_f32_16x16x32_bf16 v[196:199], a[108:111], a[16:19], v[196:199]
    v_mfma_f32_16x16x32_bf16 v[200:203], a[112:115], a[16:19], v[200:203]
    v_mfma_f32_16x16x32_bf16 v[192:195], a[140:143], a[20:23], v[192:195]
    ds_read_b128 a[16:19], v12 offset:37376
    v_cvt_pk_bf16_f32 v36, v180, v181
    v_mfma_f32_16x16x32_bf16 v[196:199], a[144:147], a[20:23], v[196:199]
    v_cvt_pk_bf16_f32 v37, v182, v183
    v_cvt_pk_bf16_f32 v38, v184, v185
    v_mfma_f32_16x16x32_bf16 v[200:203], a[148:151], a[20:23], v[200:203]
    v_cvt_pk_bf16_f32 v39, v186, v187
    s_waitcnt lgkmcnt(4)
    v_mfma_f32_16x16x32_bf16 v[192:195], a[176:179], a[24:27], v[192:195]
    ds_read_b128 a[20:23], v13 offset:37376
    s_mov_b32 s38, 516096
    v_mfma_f32_16x16x32_bf16 v[196:199], a[180:183], a[24:27], v[196:199]
    v_cvt_pk_bf16_f32 v42, v188, v189
    v_cvt_pk_bf16_f32 v43, v190, v191
    v_mfma_f32_16x16x32_bf16 v[200:203], a[184:187], a[24:27], v[200:203]
    buffer_store_dwordx4 v[36:39], v29, s[24:27], s38 offen
    s_mov_b32 s38, 172032
    v_mfma_f32_16x16x32_bf16 v[192:195], a[212:215], a[28:31], v[192:195]
    ds_read_b128 a[24:27], v14 offset:37376
    s_nop 0
    v_mfma_f32_16x16x32_bf16 v[196:199], a[216:219], a[28:31], v[196:199]
    v_permlane16_swap_b32 v40, v42
    v_permlane16_swap_b32 v41, v43
    v_mfma_f32_16x16x32_bf16 v[200:203], a[220:223], a[28:31], v[200:203]
    buffer_store_dwordx4 v[40:43], v30, s[24:27], s38 offen
    v_mfma_f32_16x16x32_bf16 v[192:195], a[32:35], a[0:3], v[192:195]
    ds_read_b128 a[28:31], v15 offset:37376
    v_mfma_f32_16x16x32_bf16 v[196:199], a[36:39], a[0:3], v[196:199]
    buffer_store_dwordx4 v[68:71], v30, s[24:27], s34 offen nt
    v_cvt_pk_bf16_f32 v60, v152, v153
    v_mfma_f32_16x16x32_bf16 v[200:203], a[40:43], a[0:3], v[200:203]
    v_cvt_pk_bf16_f32 v61, v154, v155
    s_waitcnt lgkmcnt(4)
    v_mfma_f32_16x16x32_bf16 v[192:195], a[68:71], a[4:7], v[192:195]
    ds_read_b128 a[0:3], v10 offset:23296
    v_cvt_pk_bf16_f32 v62, v156, v157
    v_mfma_f32_16x16x32_bf16 v[196:199], a[72:75], a[4:7], v[196:199]
    v_cvt_pk_bf16_f32 v63, v158, v159
    s_mov_b32 s34, 2064384
    v_mfma_f32_16x16x32_bf16 v[200:203], a[76:79], a[4:7], v[200:203]
    v_cvt_pk_bf16_f32 v72, v160, v161
    v_cvt_pk_bf16_f32 v73, v162, v163
    v_mfma_f32_16x16x32_bf16 v[192:195], a[116:119], a[8:11], v[192:195]
    ds_read_b128 a[4:7], v11 offset:23296
    v_mfma_f32_16x16x32_bf16 v[196:199], a[120:123], a[8:11], v[196:199]
    v_mfma_f32_16x16x32_bf16 v[200:203], a[124:127], a[8:11], v[200:203]
    v_mfma_f32_16x16x32_bf16 v[192:195], a[164:167], a[12:15], v[192:195]
    ds_read_b128 a[8:11], v12 offset:23296
    v_mfma_f32_16x16x32_bf16 v[196:199], a[168:171], a[12:15], v[196:199]
    v_mfma_f32_16x16x32_bf16 v[200:203], a[172:175], a[12:15], v[200:203]
    s_waitcnt lgkmcnt(4)
    v_mfma_f32_16x16x32_bf16 v[192:195], a[224:227], a[16:19], v[192:195]
    ds_read_b128 a[12:15], v13 offset:23296
    v_mfma_f32_16x16x32_bf16 v[196:199], a[228:231], a[16:19], v[196:199]
    v_mfma_f32_16x16x32_bf16 v[200:203], a[232:235], a[16:19], v[200:203]
    v_mfma_f32_16x16x32_bf16 v[192:195], a[56:59], a[20:23], v[192:195]
    ds_read_b128 a[16:19], v14 offset:23296
    v_mfma_f32_16x16x32_bf16 v[196:199], a[60:63], a[20:23], v[196:199]
    v_mfma_f32_16x16x32_bf16 v[200:203], a[64:67], a[20:23], v[200:203]
    v_mfma_f32_16x16x32_bf16 v[192:195], a[128:131], a[24:27], v[192:195]
    ds_read_b128 a[20:23], v15 offset:23296
    buffer_store_dwordx4 v[60:63], v29, s[24:27], s34 offen nt
    v_mfma_f32_16x16x32_bf16 v[196:199], a[132:135], a[24:27], v[196:199]
    v_mfma_f32_16x16x32_bf16 v[200:203], a[136:139], a[24:27], v[200:203]
    s_waitcnt lgkmcnt(4)
    v_mfma_f32_16x16x32_bf16 v[192:195], a[200:203], a[28:31], v[192:195]
    ds_read_b128 a[24:27], v10 offset:39680
    v_mfma_f32_16x16x32_bf16 v[196:199], a[204:207], a[28:31], v[196:199]
    v_mfma_f32_16x16x32_bf16 v[200:203], a[208:211], a[28:31], v[200:203]
    v_mfma_f32_16x16x32_bf16 v[204:207], a[104:107], a[0:3], v[204:207]
    ds_read_b128 a[28:31], v11 offset:39680
    v_mfma_f32_16x16x32_bf16 v[208:211], a[108:111], a[0:3], v[208:211]
    v_mfma_f32_16x16x32_bf16 v[212:215], a[112:115], a[0:3], v[212:215]
    v_mfma_f32_16x16x32_bf16 v[204:207], a[140:143], a[4:7], v[204:207]
    ds_read_b128 a[0:3], v12 offset:39680
    v_cvt_pk_bf16_f32 v32, v192, v193
    v_mfma_f32_16x16x32_bf16 v[208:211], a[144:147], a[4:7], v[208:211]
    v_cvt_pk_bf16_f32 v33, v194, v195
    v_cvt_pk_bf16_f32 v34, v196, v197
    v_mfma_f32_16x16x32_bf16 v[212:215], a[148:151], a[4:7], v[212:215]
    v_cvt_pk_bf16_f32 v35, v198, v199
    s_waitcnt lgkmcnt(4)
    v_mfma_f32_16x16x32_bf16 v[204:207], a[176:179], a[8:11], v[204:207]
    ds_read_b128 a[4:7], v13 offset:39680
    s_mov_b32 s38, 860160
    v_mfma_f32_16x16x32_bf16 v[208:211], a[180:183], a[8:11], v[208:211]
    v_cvt_pk_bf16_f32 v44, v200, v201
    v_cvt_pk_bf16_f32 v45, v202, v203
    v_mfma_f32_16x16x32_bf16 v[212:215], a[184:187], a[8:11], v[212:215]
    buffer_store_dwordx4 v[32:35], v29, s[24:27], s38 offen
    v_mfma_f32_16x16x32_bf16 v[204:207], a[212:215], a[12:15], v[204:207]
    ds_read_b128 a[8:11], v14 offset:39680
    v_mfma_f32_16x16x32_bf16 v[208:211], a[216:219], a[12:15], v[208:211]
    v_mfma_f32_16x16x32_bf16 v[212:215], a[220:223], a[12:15], v[212:215]
    v_mfma_f32_16x16x32_bf16 v[204:207], a[32:35], a[16:19], v[204:207]
    ds_read_b128 a[12:15], v15 offset:39680
    v_mfma_f32_16x16x32_bf16 v[208:211], a[36:39], a[16:19], v[208:211]
    v_mfma_f32_16x16x32_bf16 v[212:215], a[40:43], a[16:19], v[212:215]
    s_waitcnt lgkmcnt(4)
    v_mfma_f32_16x16x32_bf16 v[204:207], a[68:71], a[20:23], v[204:207]
    ds_read_b128 a[16:19], v10 offset:25600
    v_mfma_f32_16x16x32_bf16 v[208:211], a[72:75], a[20:23], v[208:211]
    v_mfma_f32_16x16x32_bf16 v[212:215], a[76:79], a[20:23], v[212:215]
    v_mfma_f32_16x16x32_bf16 v[204:207], a[116:119], a[24:27], v[204:207]
    ds_read_b128 a[20:23], v11 offset:25600
    buffer_store_dwordx2 v[72:73], v79, s[24:27], s34 offen nt
    v_mfma_f32_16x16x32_bf16 v[208:211], a[120:123], a[24:27], v[208:211]
    v_mfma_f32_16x16x32_bf16 v[212:215], a[124:127], a[24:27], v[212:215]
    v_mfma_f32_16x16x32_bf16 v[204:207], a[164:167], a[28:31], v[204:207]
    ds_read_b128 a[24:27], v12 offset:25600
    v_mfma_f32_16x16x32_bf16 v[208:211], a[168:171], a[28:31], v[208:211]
    v_mfma_f32_16x16x32_bf16 v[212:215], a[172:175], a[28:31], v[212:215]
    s_waitcnt lgkmcnt(4)
    v_mfma_f32_16x16x32_bf16 v[204:207], a[224:227], a[0:3], v[204:207]
    ds_read_b128 a[28:31], v13 offset:25600
    v_mfma_f32_16x16x32_bf16 v[208:211], a[228:231], a[0:3], v[208:211]
    v_mfma_f32_16x16x32_bf16 v[212:215], a[232:235], a[0:3], v[212:215]
    v_mfma_f32_16x16x32_bf16 v[204:207], a[56:59], a[4:7], v[204:207]
    ds_read_b128 a[0:3], v14 offset:25600
    v_mfma_f32_16x16x32_bf16 v[208:211], a[60:63], a[4:7], v[208:211]
    v_mfma_f32_16x16x32_bf16 v[212:215], a[64:67], a[4:7], v[212:215]
    v_mfma_f32_16x16x32_bf16 v[204:207], a[128:131], a[8:11], v[204:207]
    ds_read_b128 a[4:7], v15 offset:25600
    v_mfma_f32_16x16x32_bf16 v[208:211], a[132:135], a[8:11], v[208:211]
    v_mfma_f32_16x16x32_bf16 v[212:215], a[136:139], a[8:11], v[212:215]
    s_waitcnt lgkmcnt(4)
    v_mfma_f32_16x16x32_bf16 v[204:207], a[200:203], a[12:15], v[204:207]
    ds_read_b128 a[8:11], v10 offset:41984
    v_mfma_f32_16x16x32_bf16 v[208:211], a[204:207], a[12:15], v[208:211]
    v_mfma_f32_16x16x32_bf16 v[212:215], a[208:211], a[12:15], v[212:215]
    v_mfma_f32_16x16x32_bf16 v[216:219], a[104:107], a[16:19], v[216:219]
    ds_read_b128 a[12:15], v11 offset:41984
    v_mfma_f32_16x16x32_bf16 v[220:223], a[108:111], a[16:19], v[220:223]
    v_mfma_f32_16x16x32_bf16 v[224:227], a[112:115], a[16:19], v[224:227]
    v_mfma_f32_16x16x32_bf16 v[216:219], a[140:143], a[20:23], v[216:219]
    ds_read_b128 a[16:19], v12 offset:41984
    v_cvt_pk_bf16_f32 v36, v204, v205
    v_mfma_f32_16x16x32_bf16 v[220:223], a[144:147], a[20:23], v[220:223]
    v_cvt_pk_bf16_f32 v37, v206, v207
    v_cvt_pk_bf16_f32 v38, v208, v209
    v_mfma_f32_16x16x32_bf16 v[224:227], a[148:151], a[20:23], v[224:227]
    v_cvt_pk_bf16_f32 v39, v210, v211
    s_waitcnt lgkmcnt(4)
    v_mfma_f32_16x16x32_bf16 v[216:219], a[176:179], a[24:27], v[216:219]
    ds_read_b128 a[20:23], v13 offset:41984
    s_mov_b32 s38, 1204224
    v_mfma_f32_16x16x32_bf16 v[220:223], a[180:183], a[24:27], v[220:223]
    v_cvt_pk_bf16_f32 v46, v212, v213
    v_cvt_pk_bf16_f32 v47, v214, v215
    v_mfma_f32_16x16x32_bf16 v[224:227], a[184:187], a[24:27], v[224:227]
    buffer_store_dwordx4 v[36:39], v29, s[24:27], s38 offen
    s_mov_b32 s38, 860160
    v_mfma_f32_16x16x32_bf16 v[216:219], a[212:215], a[28:31], v[216:219]
    ds_read_b128 a[24:27], v14 offset:41984
    s_nop 0
    v_mfma_f32_16x16x32_bf16 v[220:223], a[216:219], a[28:31], v[220:223]
    v_permlane16_swap_b32 v44, v46
    v_permlane16_swap_b32 v45, v47
    v_mfma_f32_16x16x32_bf16 v[224:227], a[220:223], a[28:31], v[224:227]
    buffer_store_dwordx4 v[44:47], v30, s[24:27], s38 offen
    v_mfma_f32_16x16x32_bf16 v[216:219], a[32:35], a[0:3], v[216:219]
    ds_read_b128 a[28:31], v15 offset:41984
    v_mfma_f32_16x16x32_bf16 v[220:223], a[36:39], a[0:3], v[220:223]
    v_mfma_f32_16x16x32_bf16 v[224:227], a[40:43], a[0:3], v[224:227]
    s_waitcnt lgkmcnt(4)
    v_mfma_f32_16x16x32_bf16 v[216:219], a[68:71], a[4:7], v[216:219]
    ds_read_b128 a[0:3], v10 offset:27904
    v_mfma_f32_16x16x32_bf16 v[220:223], a[72:75], a[4:7], v[220:223]
    v_mfma_f32_16x16x32_bf16 v[224:227], a[76:79], a[4:7], v[224:227]
    v_mfma_f32_16x16x32_bf16 v[216:219], a[116:119], a[8:11], v[216:219]
    ds_read_b128 a[4:7], v11 offset:27904
    v_mfma_f32_16x16x32_bf16 v[220:223], a[120:123], a[8:11], v[220:223]
    v_mfma_f32_16x16x32_bf16 v[224:227], a[124:127], a[8:11], v[224:227]
    v_mfma_f32_16x16x32_bf16 v[216:219], a[164:167], a[12:15], v[216:219]
    ds_read_b128 a[8:11], v12 offset:27904
    v_mfma_f32_16x16x32_bf16 v[220:223], a[168:171], a[12:15], v[220:223]
    v_mfma_f32_16x16x32_bf16 v[224:227], a[172:175], a[12:15], v[224:227]
    s_waitcnt lgkmcnt(4)
    v_mfma_f32_16x16x32_bf16 v[216:219], a[224:227], a[16:19], v[216:219]
    ds_read_b128 a[12:15], v13 offset:27904
    v_mfma_f32_16x16x32_bf16 v[220:223], a[228:231], a[16:19], v[220:223]
    v_mfma_f32_16x16x32_bf16 v[224:227], a[232:235], a[16:19], v[224:227]
    v_mfma_f32_16x16x32_bf16 v[216:219], a[56:59], a[20:23], v[216:219]
    ds_read_b128 a[16:19], v14 offset:27904
    v_mfma_f32_16x16x32_bf16 v[220:223], a[60:63], a[20:23], v[220:223]
    v_mfma_f32_16x16x32_bf16 v[224:227], a[64:67], a[20:23], v[224:227]
    v_mfma_f32_16x16x32_bf16 v[216:219], a[128:131], a[24:27], v[216:219]
    ds_read_b128 a[20:23], v15 offset:27904
    v_mfma_f32_16x16x32_bf16 v[220:223], a[132:135], a[24:27], v[220:223]
    v_mfma_f32_16x16x32_bf16 v[224:227], a[136:139], a[24:27], v[224:227]
    s_waitcnt lgkmcnt(4)
    v_mfma_f32_16x16x32_bf16 v[216:219], a[200:203], a[28:31], v[216:219]
    ds_read_b128 a[24:27], v10 offset:44288
    v_mfma_f32_16x16x32_bf16 v[220:223], a[204:207], a[28:31], v[220:223]
    v_mfma_f32_16x16x32_bf16 v[224:227], a[208:211], a[28:31], v[224:227]
    v_mfma_f32_16x16x32_bf16 v[228:231], a[104:107], a[0:3], v[228:231]
    ds_read_b128 a[28:31], v11 offset:44288
    v_mfma_f32_16x16x32_bf16 v[232:235], a[108:111], a[0:3], v[232:235]
    v_mfma_f32_16x16x32_bf16 v[236:239], a[112:115], a[0:3], v[236:239]
    v_mfma_f32_16x16x32_bf16 v[228:231], a[140:143], a[4:7], v[228:231]
    ds_read_b128 a[0:3], v12 offset:44288
    v_cvt_pk_bf16_f32 v32, v216, v217
    v_mfma_f32_16x16x32_bf16 v[232:235], a[144:147], a[4:7], v[232:235]
    v_cvt_pk_bf16_f32 v33, v218, v219
    v_cvt_pk_bf16_f32 v34, v220, v221
    v_mfma_f32_16x16x32_bf16 v[236:239], a[148:151], a[4:7], v[236:239]
    v_cvt_pk_bf16_f32 v35, v222, v223
    s_waitcnt lgkmcnt(4)
    v_mfma_f32_16x16x32_bf16 v[228:231], a[176:179], a[8:11], v[228:231]
    ds_read_b128 a[4:7], v13 offset:44288
    s_mov_b32 s38, 1548288
    v_mfma_f32_16x16x32_bf16 v[232:235], a[180:183], a[8:11], v[232:235]
    v_cvt_pk_bf16_f32 v40, v224, v225
    v_cvt_pk_bf16_f32 v41, v226, v227
    v_mfma_f32_16x16x32_bf16 v[236:239], a[184:187], a[8:11], v[236:239]
    buffer_store_dwordx4 v[32:35], v29, s[24:27], s38 offen
    v_mfma_f32_16x16x32_bf16 v[228:231], a[212:215], a[12:15], v[228:231]
    ds_read_b128 a[8:11], v14 offset:44288
    v_mfma_f32_16x16x32_bf16 v[232:235], a[216:219], a[12:15], v[232:235]
    v_mfma_f32_16x16x32_bf16 v[236:239], a[220:223], a[12:15], v[236:239]
    v_mfma_f32_16x16x32_bf16 v[228:231], a[32:35], a[16:19], v[228:231]
    ds_read_b128 a[12:15], v15 offset:44288
    v_mfma_f32_16x16x32_bf16 v[232:235], a[36:39], a[16:19], v[232:235]
    v_mfma_f32_16x16x32_bf16 v[236:239], a[40:43], a[16:19], v[236:239]
    s_waitcnt lgkmcnt(4)
    v_mfma_f32_16x16x32_bf16 v[228:231], a[68:71], a[20:23], v[228:231]
    ds_read_b128 a[16:19], v10 offset:30208
    v_mfma_f32_16x16x32_bf16 v[232:235], a[72:75], a[20:23], v[232:235]
    v_mfma_f32_16x16x32_bf16 v[236:239], a[76:79], a[20:23], v[236:239]
    v_mfma_f32_16x16x32_bf16 v[228:231], a[116:119], a[24:27], v[228:231]
    ds_read_b128 a[20:23], v11 offset:30208
    v_mfma_f32_16x16x32_bf16 v[232:235], a[120:123], a[24:27], v[232:235]
    v_mfma_f32_16x16x32_bf16 v[236:239], a[124:127], a[24:27], v[236:239]
    v_mfma_f32_16x16x32_bf16 v[228:231], a[164:167], a[28:31], v[228:231]
    ds_read_b128 a[24:27], v12 offset:30208
    v_mfma_f32_16x16x32_bf16 v[232:235], a[168:171], a[28:31], v[232:235]
    v_mfma_f32_16x16x32_bf16 v[236:239], a[172:175], a[28:31], v[236:239]
    s_waitcnt lgkmcnt(4)
    v_mfma_f32_16x16x32_bf16 v[228:231], a[224:227], a[0:3], v[228:231]
    ds_read_b128 a[28:31], v13 offset:30208
    v_mfma_f32_16x16x32_bf16 v[232:235], a[228:231], a[0:3], v[232:235]
    v_mfma_f32_16x16x32_bf16 v[236:239], a[232:235], a[0:3], v[236:239]
    v_mfma_f32_16x16x32_bf16 v[228:231], a[56:59], a[4:7], v[228:231]
    ds_read_b128 a[0:3], v14 offset:30208
    v_mfma_f32_16x16x32_bf16 v[232:235], a[60:63], a[4:7], v[232:235]
    v_mfma_f32_16x16x32_bf16 v[236:239], a[64:67], a[4:7], v[236:239]
    v_mfma_f32_16x16x32_bf16 v[228:231], a[128:131], a[8:11], v[228:231]
    ds_read_b128 a[4:7], v15 offset:30208
    v_mfma_f32_16x16x32_bf16 v[232:235], a[132:135], a[8:11], v[232:235]
    v_mfma_f32_16x16x32_bf16 v[236:239], a[136:139], a[8:11], v[236:239]
    s_waitcnt lgkmcnt(4)
    v_mfma_f32_16x16x32_bf16 v[228:231], a[200:203], a[12:15], v[228:231]
    ds_read_b128 a[8:11], v10 offset:46592
    v_mfma_f32_16x16x32_bf16 v[232:235], a[204:207], a[12:15], v[232:235]
    v_mfma_f32_16x16x32_bf16 v[236:239], a[208:211], a[12:15], v[236:239]
    v_mfma_f32_16x16x32_bf16 v[240:243], a[104:107], a[16:19], v[240:243]
    ds_read_b128 a[12:15], v11 offset:46592
    v_mfma_f32_16x16x32_bf16 v[244:247], a[108:111], a[16:19], v[244:247]
    v_mfma_f32_16x16x32_bf16 v[248:251], a[112:115], a[16:19], v[248:251]
    v_mfma_f32_16x16x32_bf16 v[240:243], a[140:143], a[20:23], v[240:243]
    ds_read_b128 a[16:19], v12 offset:46592
    v_cvt_pk_bf16_f32 v36, v228, v229
    v_mfma_f32_16x16x32_bf16 v[244:247], a[144:147], a[20:23], v[244:247]
    v_cvt_pk_bf16_f32 v37, v230, v231
    v_cvt_pk_bf16_f32 v38, v232, v233
    v_mfma_f32_16x16x32_bf16 v[248:251], a[148:151], a[20:23], v[248:251]
    v_cvt_pk_bf16_f32 v39, v234, v235
    s_waitcnt lgkmcnt(4)
    v_mfma_f32_16x16x32_bf16 v[240:243], a[176:179], a[24:27], v[240:243]
    ds_read_b128 a[20:23], v13 offset:46592
    s_mov_b32 s38, 1892352
    v_mfma_f32_16x16x32_bf16 v[244:247], a[180:183], a[24:27], v[244:247]
    v_cvt_pk_bf16_f32 v42, v236, v237
    v_cvt_pk_bf16_f32 v43, v238, v239
    v_mfma_f32_16x16x32_bf16 v[248:251], a[184:187], a[24:27], v[248:251]
    buffer_store_dwordx4 v[36:39], v29, s[24:27], s38 offen
    s_mov_b32 s38, 1548288
    v_mfma_f32_16x16x32_bf16 v[240:243], a[212:215], a[28:31], v[240:243]
    ds_read_b128 a[24:27], v14 offset:46592
    s_nop 0
    v_mfma_f32_16x16x32_bf16 v[244:247], a[216:219], a[28:31], v[244:247]
    v_permlane16_swap_b32 v40, v42
    v_permlane16_swap_b32 v41, v43
    v_mfma_f32_16x16x32_bf16 v[248:251], a[220:223], a[28:31], v[248:251]
    buffer_store_dwordx4 v[40:43], v30, s[24:27], s38 offen
    v_mfma_f32_16x16x32_bf16 v[240:243], a[32:35], a[0:3], v[240:243]
    ds_read_b128 a[28:31], v15 offset:46592
    v_mfma_f32_16x16x32_bf16 v[244:247], a[36:39], a[0:3], v[244:247]
    v_mfma_f32_16x16x32_bf16 v[248:251], a[40:43], a[0:3], v[248:251]
    s_waitcnt lgkmcnt(4)
    v_mfma_f32_16x16x32_bf16 v[240:243], a[68:71], a[4:7], v[240:243]
    v_mfma_f32_16x16x32_bf16 v[244:247], a[72:75], a[4:7], v[244:247]
    v_mfma_f32_16x16x32_bf16 v[248:251], a[76:79], a[4:7], v[248:251]
    v_mfma_f32_16x16x32_bf16 v[240:243], a[116:119], a[8:11], v[240:243]
    v_mfma_f32_16x16x32_bf16 v[244:247], a[120:123], a[8:11], v[244:247]
    v_mfma_f32_16x16x32_bf16 v[248:251], a[124:127], a[8:11], v[248:251]
    v_mfma_f32_16x16x32_bf16 v[240:243], a[164:167], a[12:15], v[240:243]
    v_mfma_f32_16x16x32_bf16 v[244:247], a[168:171], a[12:15], v[244:247]
    v_mfma_f32_16x16x32_bf16 v[248:251], a[172:175], a[12:15], v[248:251]
    s_waitcnt lgkmcnt(1)
    v_mfma_f32_16x16x32_bf16 v[240:243], a[224:227], a[16:19], v[240:243]
    v_mfma_f32_16x16x32_bf16 v[244:247], a[228:231], a[16:19], v[244:247]
    v_mfma_f32_16x16x32_bf16 v[248:251], a[232:235], a[16:19], v[248:251]
    v_mfma_f32_16x16x32_bf16 v[240:243], a[56:59], a[20:23], v[240:243]
    v_mfma_f32_16x16x32_bf16 v[244:247], a[60:63], a[20:23], v[244:247]
    v_mfma_f32_16x16x32_bf16 v[248:251], a[64:67], a[20:23], v[248:251]
    v_mfma_f32_16x16x32_bf16 v[240:243], a[128:131], a[24:27], v[240:243]
    v_mfma_f32_16x16x32_bf16 v[244:247], a[132:135], a[24:27], v[244:247]
    v_mfma_f32_16x16x32_bf16 v[248:251], a[136:139], a[24:27], v[248:251]
    s_waitcnt lgkmcnt(0)
    v_mfma_f32_16x16x32_bf16 v[240:243], a[200:203], a[28:31], v[240:243]
    v_mfma_f32_16x16x32_bf16 v[244:247], a[204:207], a[28:31], v[244:247]
    v_mfma_f32_16x16x32_bf16 v[248:251], a[208:211], a[28:31], v[248:251]
    s_nop 7
    v_cvt_pk_bf16_f32 v32, v240, v241
    v_cvt_pk_bf16_f32 v33, v242, v243
    v_cvt_pk_bf16_f32 v34, v244, v245
    v_cvt_pk_bf16_f32 v35, v246, v247
    s_mov_b32 s38, 2236416
    v_cvt_pk_bf16_f32 v44, v248, v249
    v_cvt_pk_bf16_f32 v45, v250, v251
    buffer_store_dwordx4 v[32:35], v29, s[24:27], s38 offen
    buffer_store_dwordx2 v[44:45], v79, s[24:27], s38 offen
L_end2:
    s_endpgm
L_slowflag:
    s_mov_b32 s92, 0
L_slowflag1:
    global_load_dword v0, v31, s[10:11] offset:-4 sc1
    s_add_u32 s92, s92, 1
    s_waitcnt vmcnt(0)
    v_cmp_ne_u32 s[100:101], 0, v0
    s_cmp_eq_u32 s100, -1
    s_cbranch_scc1 L_flagok
    s_sleep 2
    s_cmp_lt_u32 s92, 0x20000
    s_cbranch_scc1 L_slowflag1
    s_branch L_flagok
L_slowflagb:
    s_mov_b32 s92, 0
L_slowflag1b:
    global_load_dword v0, v31, s[10:11] sc1
    s_add_u32 s92, s92, 1
    s_waitcnt vmcnt(0)
    v_cmp_ne_u32 s[100:101], 0, v0
    s_cmp_eq_u64 s[100:101], -1
    s_cbranch_scc1 L_flagokb
    s_sleep 2
    s_cmp_lt_u32 s92, 0x20000
    s_cbranch_scc1 L_slowflag1b
    s_branch L_flagokb
.fill (32768 + 256 - (. - L_main)) / 4, 4, 0xBF800000
.section .rodata,"a"
.p2align 6
.amdhsa_kernel standalone__dilated_atrous__vision_kernel
  .amdhsa_next_free_vgpr 512
  .amdhsa_next_free_sgpr 102
  .amdhsa_accum_offset 256
  .amdhsa_group_segment_fixed_size 0
  .amdhsa_ieee_mode 0
  .amdhsa_kernarg_size 40
  .amdhsa_user_sgpr_count 2
  .amdhsa_user_sgpr_kernarg_segment_ptr 1
  .amdhsa_system_sgpr_workgroup_id_x 1
.end_amdhsa_kernel
```
